```python
import torch

def _softmax(x, axis=-1):
    return torch.softmax(x, dim=axis)
def _gelu(x):
    return torch.nn.functional.gelu(x, approximate="tanh")
def _silu(x):
    return torch.nn.functional.silu(x)
def _sigmoid(x):
    return torch.sigmoid(x)
def _layernorm(x, axis=-1, eps=1e-5):
    m = x.mean(dim=axis, keepdim=True)
    v = x.var(dim=axis, keepdim=True, unbiased=False)
    return (x - m) / torch.sqrt(v + eps)
def _scatter_add(tgt, idx, src, axis=0):
    return tgt.clone().index_add_(axis, idx, src)
def _segment_sum(src, seg, n):
    out = torch.zeros((n,) + src.shape[1:], dtype=src.dtype)
    return out.index_add_(0, seg, src)
def _pad(x, pw):
    flat = tuple(v for pair in reversed(pw) for v in pair)
    return torch.nn.functional.pad(x, flat)

kernel_name = 'sequential_preLN__sliding_block_cached__glu_gated_bilinear__decode'

def setup_inputs():

    _w = (lambda a: (lambda t: t.to(torch.bfloat16) if t.is_floating_point() else t)(torch.as_tensor(a)))
    def _A_setup():
        B, Sq, D = 2, 1, 512
        Hq, Hkv, Sk, Dh = 32, 8, 32768, 128
        assert Hq % Hkv == 0, (Hq, Hkv)
        return {
            "x": _w((lambda *s: torch.randn(*s, dtype=torch.bfloat16) * 0.05)(B, Sq, D)),
            "k_cache": _w((lambda *s: torch.randn(*s, dtype=torch.bfloat16) * 1.6)(B, Hkv, Sk, Dh)),
            "v_cache": _w((lambda *s: torch.randn(*s, dtype=torch.bfloat16) * 0.8)(B, Hkv, Sk, Dh)),
            "wq": _w((lambda *s: torch.randn(*s, dtype=torch.bfloat16) * 1.6)(D, Hq * Dh) * (D ** -0.5)),
            "wo": _w((lambda *s: torch.randn(*s, dtype=torch.bfloat16) * 0.8)(Hq * Dh, D) * ((Hq * Dh) ** -0.5)),
        }
    _A_in = _A_setup()

    def _B_setup():
        B, S, D, F = 2, 1, 512, 1792
        return {
            "x": _w((lambda *s: torch.randn(*s, dtype=torch.bfloat16) * 0.05)(B, S, D)),
            "w_gate": _w((lambda *s: torch.randn(*s, dtype=torch.bfloat16) * 0.4)(D, F) * (D ** -0.5)),
            "w_up": _w((lambda *s: torch.randn(*s, dtype=torch.bfloat16) * 0.4)(D, F) * (D ** -0.5)),
            "w_down": _w((lambda *s: torch.randn(*s, dtype=torch.bfloat16) * 0.4)(F, D) * (F ** -0.5)),
        }
    _B_in = _B_setup()

    return {
        "A_x": _A_in["x"],
        "A_k_cache": _A_in["k_cache"],
        "A_v_cache": _A_in["v_cache"],
        "A_wq": _A_in["wq"],
        "A_wo": _A_in["wo"],
        "B_x": _B_in["x"],
        "B_w_gate": _B_in["w_gate"],
        "B_w_up": _B_in["w_up"],
        "B_w_down": _B_in["w_down"],
    }

def reference(A_x, A_k_cache, A_v_cache, A_wq, A_wo, B_x, B_w_gate, B_w_up, B_w_down):
    def _A_ref(x, k_cache, v_cache, wq, wo):
        B, Sq, D = x.shape
        Hq, Dh = 32, 128
        Hkv, Sk = k_cache.shape[1], k_cache.shape[2]
        W = min(4096, max(256, Sk // 4))
        rep = Hq // Hkv
        q = (lambda x, *d: x.permute(*d))((x @ wq).reshape(B, Sq, Hq, Dh), 0, 2, 1, 3)
        k = (lambda x, n, axis: torch.repeat_interleave(x, n, dim=axis))(k_cache[:, :, Sk - W:, :], rep, axis=1)
        v = (lambda x, n, axis: torch.repeat_interleave(x, n, dim=axis))(v_cache[:, :, Sk - W:, :], rep, axis=1)
        scores = torch.einsum("bhqd,bhkd->bhqk", q, k) * (Dh ** -0.5)
        p = _softmax(scores, axis=-1)
        o = torch.einsum("bhqk,bhkd->bhqd", p, v)
        return (lambda x, *d: x.permute(*d))(o, 0, 2, 1, 3).reshape(B, Sq, Hq * Dh) @ wo

    def _B_ref(x, w_gate, w_up, w_down):
        g = torch.einsum("bsd,df->bsf", x, w_gate)
        u = torch.einsum("bsd,df->bsf", x, w_up)
        h = g * u
        return torch.einsum("bsf,fd->bsd", h, w_down)

    x = A_x
    h = x + _A_ref(_layernorm(x, axis=-1), A_k_cache, A_v_cache, A_wq, A_wo)
    h2 = h + _B_ref(_layernorm(h, axis=-1), B_w_gate, B_w_up, B_w_down)
    return h2
```

```asm
; @launch grid=(256,1,1) block=(1024,1,1) lds=155648
.amdgcn_target "amdgcn-amd-amdhsa--gfx950"
.text
.globl sequential_preLN__sliding_block_cached__glu_gated_bilinear__decode_kernel
.p2align 8
.type sequential_preLN__sliding_block_cached__glu_gated_bilinear__decode_kernel,@function
sequential_preLN__sliding_block_cached__glu_gated_bilinear__decode_kernel:
    s_cmp_ge_u32 s2, 256
    s_cbranch_scc1 L_exit0
    s_load_dwordx16 s[4:19], s[0:1], 0
    s_load_dwordx8 s[20:27], s[0:1], 64
    v_lshrrev_b32 v1, 6, v0
    v_and_b32 v0, 63, v0
    s_and_b32 s29, s2, 7
    s_lshr_b32 s30, s2, 3
    v_readfirstlane_b32 s28, v1
    v_lshrrev_b32 v2, 4, v0
    v_and_b32 v3, 15, v0
    s_and_b32 s31, s30, 1
    s_lshr_b32 s32, s30, 1
    s_xor_b32 s32, s32, 8
    s_mov_b32 s39, 0x20000
    s_mov_b32 s43, s39
    s_brev_b32 s38, 4
    v_lshlrev_b32 v16, 4, v0
    s_cmpk_eq_u32 s2, 18
    s_cselect_b64 vcc, 32, 0
    s_bitcmp1_b32 vcc_lo, s28
    s_cbranch_scc1 L_pr
    s_cmp_eq_u32 s28, 4
    s_cbranch_scc1 L_q
    s_mov_b32 s64, 0x11110111
    s_mov_b32 s65, 0xff7f3377
    s_bitcmp1_b32 s29, 0
    s_cselect_b32 s64, 0x11130313, s64
    s_cselect_b32 s65, 0x33ff3377, s65
    s_lshl_b32 s3, s32, 2
    s_bfm_b64 s[66:67], s3, 0
    s_and_b64 s[66:67], s[66:67], s[64:65]
    s_bcnt1_i32_b64 s34, s[66:67]
    s_lshr_b64 s[64:65], s[64:65], s3
    s_and_b32 s64, s64, 15
    s_bcnt1_i32_b32 s69, s64
    s_lshl2_add_u32 s34, s3, s34
    s_sub_u32 s64, 896, s32
    s_lshl1_add_u32 s34, s64, s34
    s_lshl_b32 s34, s34, 12
    s_lshl_b32 s3, s31, 3
    s_add_u32 s3, s3, s29
    s_lshl_b32 s3, s3, 23
    s_add_u32 s34, s34, s3
    s_cmp_lt_u32 s28, 4
    s_cbranch_scc1 L_g
    s_cbranch_vccz L_pb_1
    s_barrier
L_pb_1:
    s_barrier
    s_cmp_eq_u32 s28, 6
    s_cbranch_scc1 L_t_a
    s_cmp_eq_u32 s28, 7
    s_cbranch_scc1 L_t_g
    s_cmp_eq_u32 s28, 8
    s_cbranch_scc1 L_t_q
    s_cmp_eq_u32 s28, 9
    s_cbranch_scc1 L_t_k
    s_cmp_eq_u32 s28, 10
    s_cbranch_scc1 L_t_s
    s_cmp_eq_u32 s28, 11
    s_cbranch_scc1 L_t_u
    s_cmp_eq_u32 s28, 12
    s_cbranch_scc1 L_t_v
    s_cmp_eq_u32 s28, 13
    s_cbranch_scc1 L_t_o
    s_cmp_eq_u32 s28, 14
    s_cbranch_scc1 L_t_w
    s_cmp_eq_u32 s28, 15
    s_cbranch_scc1 L_t_r
    s_branch L_att
L_pr:
    s_bfm_b64 exec, 32, 0
    s_movk_i32 s52, 0x4000
    s_movk_i32 s53, 0x6000
    s_waitcnt lgkmcnt(0)
    s_mov_b64 s[36:37], s[26:27]
    buffer_store_dwordx4 v[0:3], v16, s[36:39], s52 offen sc1
    buffer_store_dwordx4 v[0:3], v16, s[36:39], s53 offen sc1
    s_barrier
    s_load_dword s60, s[26:27], 0
    s_waitcnt vmcnt(1)
    s_memtime s[64:65]
    s_waitcnt vmcnt(0)
    s_memtime s[66:67]
    s_barrier
    s_branch L_go
L_exit0:
    s_endpgm
L_g:
    s_lshl_b32 s54, s28, 12
    s_add_u32 s53, s34, s54
    s_mov_b32 m0, s54
    v_lshlrev_b32 v8, 2, v2
    v_xor_b32 v8, v8, v3
    v_lshlrev_b32 v8, 4, v8
    v_lshl_add_u32 v8, v2, 8, v8
    v_xor_b32 v9, 16, v8
    v_xor_b32 v10, 32, v8
    v_xor_b32 v11, 48, v8
    s_brev_b32 s42, 16
    s_movk_i32 s55, 0x4000
    s_sub_u32 s51, s69, s28
    s_add_u32 s51, s51, 13
    s_lshr_b32 s51, s51, 2
    s_cmp_lt_u32 s51, 0
    s_waitcnt lgkmcnt(0)
    s_mov_b64 s[40:41], s[6:7]
    s_cbranch_vccz L_pb_2
    s_barrier
L_pb_2:
    s_barrier
    s_cmp_eq_u32 s51, 4
    s_cbranch_scc1 L_kme
    s_branch L_kle
L_q:
    s_setprio 3
    v_mov_b32 v12, -1
    v_mov_b32 v13, -1
    v_mov_b32 v14, -1
    v_mov_b32 v15, -1
    v_lshlrev_b32 v17, 2, v0
    v_add_u32 v17, 148480, v17
    v_mov_b32 v20, 0
    ds_write_b32 v17, v20 offset:256
    ds_write_b32 v17, v12
    v_lshrrev_b32 v4, 3, v0
    v_and_b32 v5, 2, v4
    v_xor_b32 v5, v5, v0
    v_and_b32 v5, 7, v5
    v_lshlrev_b32 v5, 4, v5
    v_lshl_add_u32 v8, v4, 13, v5
    v_xor_b32 v9, 64, v8
    v_add_u32 v9, 64512, v9
    v_add_u32 v10, 129024, v8
    v_add_u32 v11, 129024, v9
    v_lshlrev_b32 v7, 5, v0
    s_lshr_b32 s59, s30, 2
    s_and_b32 s57, s30, 3
    s_lshl3_add_u32 s58, s29, s59
    s_lshl_b32 s52, s58, 7
    s_lshl_b32 s53, s57, 20
    s_add_u32 s52, s52, s53
    s_mov_b32 m0, s43
    s_movk_i32 s42, 2048
    s_lshl_b32 s46, s43, 5
    s_mov_b32 s47, s43
    s_lshl_b32 s55, s43, 1
    s_movk_i32 s54, 0x1000
    s_and_b32 s3, s59, 4
    s_mul_i32 s3, s3, 31
    s_add_u32 s3, s3, s59
    s_and_b32 s56, s2, 31
    s_lshl2_add_u32 s3, s56, s3
    s_addk_i32 s3, 256
    s_lshl_b32 s3, s3, 12
    s_waitcnt lgkmcnt(0)
    s_mov_b64 s[40:41], s[4:5]
    s_mov_b64 s[44:45], s[10:11]
    s_mov_b64 s[36:37], s[26:27]
    s_cbranch_vccz L_pb_3
    s_barrier
L_pb_3:
    buffer_load_dwordx4 v[40:43], v7, s[40:43], 0 offen
    buffer_load_dwordx4 v[44:47], v7, s[40:43], 0 offen offset:16
    buffer_load_dwordx4 v8, s[44:47], s52 offen offset:0 nt lds
    buffer_load_dwordx4 v9, s[44:47], s52 offen offset:1024 nt lds
    buffer_load_dwordx4 v10, s[44:47], s52 offen offset:2048 nt lds
    buffer_load_dwordx4 v11, s[44:47], s52 offen offset:3072 nt lds
    s_add_u32 m0, m0, s54
    s_add_u32 s52, s52, s55
    buffer_load_dwordx4 v8, s[44:47], s52 offen offset:0 nt lds
    buffer_load_dwordx4 v9, s[44:47], s52 offen offset:1024 nt lds
    buffer_load_dwordx4 v10, s[44:47], s52 offen offset:2048 nt lds
    buffer_load_dwordx4 v11, s[44:47], s52 offen offset:3072 nt lds
    s_add_u32 m0, m0, s54
    s_add_u32 s52, s52, s55
    buffer_load_dwordx4 v8, s[44:47], s52 offen offset:0 nt lds
    buffer_load_dwordx4 v9, s[44:47], s52 offen offset:1024 nt lds
    buffer_load_dwordx4 v10, s[44:47], s52 offen offset:2048 nt lds
    buffer_load_dwordx4 v11, s[44:47], s52 offen offset:3072 nt lds
    s_add_u32 m0, m0, s54
    s_add_u32 s52, s52, s55
    buffer_load_dwordx4 v8, s[44:47], s52 offen offset:0 nt lds
    buffer_load_dwordx4 v9, s[44:47], s52 offen offset:1024 nt lds
    buffer_load_dwordx4 v10, s[44:47], s52 offen offset:2048 nt lds
    buffer_load_dwordx4 v11, s[44:47], s52 offen offset:3072 nt lds
    s_load_dword s60, s[26:27], 0
    s_barrier
    buffer_store_dwordx4 v[12:15], v16, s[36:39], s3 offen offset:0 sc1
    buffer_store_dwordx4 v[12:15], v16, s[36:39], s3 offen offset:1024 sc1
    buffer_store_dwordx4 v[12:15], v16, s[36:39], s3 offen offset:2048 sc1
    buffer_store_dwordx4 v[12:15], v16, s[36:39], s3 offen offset:3072 sc1
    s_branch L_q1
.p2alignl 10, 0xbf810000
L_km:
L_kme:
    s_waitcnt vmcnt(6)
    buffer_load_dwordx4 v8, s[40:43], s53 offen offset:0 nt lds
    s_waitcnt vmcnt(6)
    buffer_load_dwordx4 v9, s[40:43], s53 offen offset:1024 nt lds
    s_waitcnt vmcnt(6)
    buffer_load_dwordx4 v10, s[40:43], s53 offen offset:2048 nt lds
    s_waitcnt vmcnt(6)
    buffer_load_dwordx4 v11, s[40:43], s53 offen offset:3072 nt lds
L_km1:
    s_add_u32 m0, m0, s55
    s_add_u32 s53, s53, s55
    s_add_u32 s51, s51, -1
    s_cbranch_scc1 L_km
    s_branch L_klx
L_kl:
L_kle:
    s_waitcnt vmcnt(4)
    buffer_load_dwordx4 v8, s[40:43], s53 offen offset:0 nt lds
    s_waitcnt vmcnt(4)
    buffer_load_dwordx4 v9, s[40:43], s53 offen offset:1024 nt lds
    s_waitcnt vmcnt(4)
    buffer_load_dwordx4 v10, s[40:43], s53 offen offset:2048 nt lds
    s_waitcnt vmcnt(4)
    buffer_load_dwordx4 v11, s[40:43], s53 offen offset:3072 nt lds
L_kl1:
    s_add_u32 m0, m0, s55
    s_add_u32 s53, s53, s55
    s_add_u32 s51, s51, -1
    s_cbranch_scc1 L_kl
    s_branch L_klx
L_q1:
    v_bfe_u32 v4, v0, 2, 2
    v_lshl_add_u32 v5, v2, 3, v4
    v_lshlrev_b32 v5, 7, v5
    v_and_b32 v6, 3, v0
    v_lshl_add_u32 v5, v6, 3, v5
    v_lshrrev_b32 v4, 1, v4
    v_and_b32 v6, 1, v2
    v_lshl_add_u32 v4, v6, 1, v4
    v_lshl_add_u32 v5, v4, 5, v5
    v_add_u32 v48, 131072, v5
    v_xor_b32 v49, 32, v48
    v_xor_b32 v50, 64, v48
    v_xor_b32 v51, 96, v48
    v_add_u32 v7, 149504, v7
    s_lshl_b32 s53, s57, 8
    s_add_u32 s53, s53, 149504
    v_bfe_u32 v4, v0, 2, 1
    v_lshlrev_b32 v10, 10, v4
    v_lshl_add_u32 v10, v2, 4, v10
    v_add_u32 v10, s53, v10
    v_lshlrev_b32 v11, 13, v4
    v_lshl_add_u32 v11, v2, 6, v11
    v_and_b32 v4, 3, v0
    v_lshl_add_u32 v11, v4, 4, v11
    s_lshl_b32 s55, s29, 14
    s_lshl3_add_u32 s53, s57, s59
    s_lshl_b32 s53, s53, 8
    s_add_u32 s55, s55, s53
    s_add_u32 s55, s55, 0x40000
    s_mov_b32 s74, 0x00ff00ff
    s_mov_b32 s75, 0x00ff00ff
    s_add_u32 s76, s55, 131072
    s_waitcnt lgkmcnt(0)
    s_waitcnt vmcnt(20)
    s_add_u32 s60, s60, 0x7f4a7c15
    v_lshlrev_b32 v20, 16, v40
    v_and_b32 v21, 0xffff0000, v40
    v_lshlrev_b32 v22, 16, v41
    v_and_b32 v23, 0xffff0000, v41
    v_lshlrev_b32 v24, 16, v42
    v_and_b32 v25, 0xffff0000, v42
    v_lshlrev_b32 v26, 16, v43
    v_and_b32 v27, 0xffff0000, v43
    v_lshlrev_b32 v28, 16, v44
    v_and_b32 v29, 0xffff0000, v44
    v_lshlrev_b32 v30, 16, v45
    v_and_b32 v31, 0xffff0000, v45
    v_lshlrev_b32 v32, 16, v46
    v_and_b32 v33, 0xffff0000, v46
    v_lshlrev_b32 v34, 16, v47
    v_and_b32 v35, 0xffff0000, v47
    v_pk_add_f32 v[36:37], v[20:21], v[22:23]
    v_pk_add_f32 v[36:37], v[36:37], v[24:25]
    v_pk_add_f32 v[36:37], v[36:37], v[26:27]
    v_pk_add_f32 v[36:37], v[36:37], v[28:29]
    v_pk_add_f32 v[36:37], v[36:37], v[30:31]
    v_pk_add_f32 v[36:37], v[36:37], v[32:33]
    v_pk_add_f32 v[36:37], v[36:37], v[34:35]
    v_add_f32 v36, v36, v37
    s_nop 1
    v_add_f32_dpp v36, v36, v36 row_ror:1 row_mask:0xf bank_mask:0xf
    s_nop 1
    v_add_f32_dpp v36, v36, v36 row_ror:2 row_mask:0xf bank_mask:0xf
    s_nop 1
    v_add_f32_dpp v36, v36, v36 row_ror:4 row_mask:0xf bank_mask:0xf
    s_nop 1
    v_add_f32_dpp v36, v36, v36 row_ror:8 row_mask:0xf bank_mask:0xf
    v_mov_b32 v37, v36
    s_nop 1
    v_permlane16_swap_b32 v36, v37
    v_add_f32 v36, v36, v37
    v_mul_f32 v36, 0x3b000000, v36
    v_sub_f32 v38, v20, v36
    v_mul_f32 v39, v38, v38
    v_sub_f32 v38, v21, v36
    v_fmac_f32 v39, v38, v38
    v_sub_f32 v38, v22, v36
    v_fmac_f32 v39, v38, v38
    v_sub_f32 v38, v23, v36
    v_fmac_f32 v39, v38, v38
    v_sub_f32 v38, v24, v36
    v_fmac_f32 v39, v38, v38
    v_sub_f32 v38, v25, v36
    v_fmac_f32 v39, v38, v38
    v_sub_f32 v38, v26, v36
    v_fmac_f32 v39, v38, v38
    v_sub_f32 v38, v27, v36
    v_fmac_f32 v39, v38, v38
    v_sub_f32 v38, v28, v36
    v_fmac_f32 v39, v38, v38
    v_sub_f32 v38, v29, v36
    v_fmac_f32 v39, v38, v38
    v_sub_f32 v38, v30, v36
    v_fmac_f32 v39, v38, v38
    v_sub_f32 v38, v31, v36
    v_fmac_f32 v39, v38, v38
    v_sub_f32 v38, v32, v36
    v_fmac_f32 v39, v38, v38
    v_sub_f32 v38, v33, v36
    v_fmac_f32 v39, v38, v38
    v_sub_f32 v38, v34, v36
    v_fmac_f32 v39, v38, v38
    v_sub_f32 v38, v35, v36
    v_fmac_f32 v39, v38, v38
    s_nop 1
    v_add_f32_dpp v39, v39, v39 row_ror:1 row_mask:0xf bank_mask:0xf
    s_nop 1
    v_add_f32_dpp v39, v39, v39 row_ror:2 row_mask:0xf bank_mask:0xf
    s_nop 1
    v_add_f32_dpp v39, v39, v39 row_ror:4 row_mask:0xf bank_mask:0xf
    s_nop 1
    v_add_f32_dpp v39, v39, v39 row_ror:8 row_mask:0xf bank_mask:0xf
    v_mov_b32 v37, v39
    s_nop 1
    v_permlane16_swap_b32 v39, v37
    v_add_f32 v39, v39, v37
    v_mul_f32 v39, 0x3b000000, v39
    v_cvt_pk_bf16_f32 v36, v36, v36
    v_lshlrev_b32 v36, 16, v36
    v_cvt_pk_bf16_f32 v39, v39, v39
    v_lshlrev_b32 v39, 16, v39
    v_add_f32 v39, 0x3727c5ac, v39
    v_cvt_pk_bf16_f32 v39, v39, v39
    v_lshlrev_b32 v39, 16, v39
    v_sqrt_f32 v39, v39
    s_nop 0
    v_cvt_pk_bf16_f32 v39, v39, v39
    v_lshlrev_b32 v39, 16, v39
    v_rcp_f32 v39, v39
    v_sub_f32 v20, v20, v36
    v_sub_f32 v21, v21, v36
    v_cvt_pk_bf16_f32 v38, v20, v21
    v_lshlrev_b32 v20, 16, v38
    v_and_b32 v21, 0xffff0000, v38
    v_mul_f32 v20, v20, v39
    v_mul_f32 v21, v21, v39
    v_cvt_pk_bf16_f32 v40, v20, v21
    v_sub_f32 v22, v22, v36
    v_sub_f32 v23, v23, v36
    v_cvt_pk_bf16_f32 v38, v22, v23
    v_lshlrev_b32 v22, 16, v38
    v_and_b32 v23, 0xffff0000, v38
    v_mul_f32 v22, v22, v39
    v_mul_f32 v23, v23, v39
    v_cvt_pk_bf16_f32 v41, v22, v23
    v_sub_f32 v24, v24, v36
    v_sub_f32 v25, v25, v36
    v_cvt_pk_bf16_f32 v38, v24, v25
    v_lshlrev_b32 v24, 16, v38
    v_and_b32 v25, 0xffff0000, v38
    v_mul_f32 v24, v24, v39
    v_mul_f32 v25, v25, v39
    v_cvt_pk_bf16_f32 v42, v24, v25
    v_sub_f32 v26, v26, v36
    v_sub_f32 v27, v27, v36
    v_cvt_pk_bf16_f32 v38, v26, v27
    v_lshlrev_b32 v26, 16, v38
    v_and_b32 v27, 0xffff0000, v38
    v_mul_f32 v26, v26, v39
    v_mul_f32 v27, v27, v39
    v_cvt_pk_bf16_f32 v43, v26, v27
    s_branch L_b_a
.rept 288
    s_endpgm
.endr
.p2alignl 10, 0xbf810000
L_t_a:
    s_branch L_att
L_b_a:
    v_sub_f32 v28, v28, v36
    v_sub_f32 v29, v29, v36
    v_cvt_pk_bf16_f32 v38, v28, v29
    v_lshlrev_b32 v28, 16, v38
    v_and_b32 v29, 0xffff0000, v38
    v_mul_f32 v28, v28, v39
    v_mul_f32 v29, v29, v39
    v_cvt_pk_bf16_f32 v44, v28, v29
    v_sub_f32 v30, v30, v36
    v_sub_f32 v31, v31, v36
    v_cvt_pk_bf16_f32 v38, v30, v31
    v_lshlrev_b32 v30, 16, v38
    v_and_b32 v31, 0xffff0000, v38
    v_mul_f32 v30, v30, v39
    v_mul_f32 v31, v31, v39
    v_cvt_pk_bf16_f32 v45, v30, v31
    v_sub_f32 v32, v32, v36
    v_sub_f32 v33, v33, v36
    v_cvt_pk_bf16_f32 v38, v32, v33
    v_lshlrev_b32 v32, 16, v38
    v_and_b32 v33, 0xffff0000, v38
    v_mul_f32 v32, v32, v39
    v_mul_f32 v33, v33, v39
    v_cvt_pk_bf16_f32 v46, v32, v33
    v_sub_f32 v34, v34, v36
    v_sub_f32 v35, v35, v36
    v_cvt_pk_bf16_f32 v38, v34, v35
    v_lshlrev_b32 v34, 16, v38
    v_and_b32 v35, 0xffff0000, v38
    v_mul_f32 v34, v34, v39
    v_mul_f32 v35, v35, v39
    v_cvt_pk_bf16_f32 v47, v34, v35
    ds_write_b128 v7, v[40:43]
    ds_write_b128 v7, v[44:47] offset:16
    ds_read_b128 v[20:23], v10 offset:0
    ds_read_b128 v[24:27], v10 offset:64
    ds_read_b128 v[28:31], v10 offset:128
    ds_read_b128 v[32:35], v10 offset:192
    s_waitcnt vmcnt(16)
    ds_read_b64_tr_b16 v[64:65], v48 offset:0
    ds_read_b64_tr_b16 v[66:67], v48 offset:512
    ds_read_b64_tr_b16 v[68:69], v49 offset:0
    ds_read_b64_tr_b16 v[70:71], v49 offset:512
    ds_read_b64_tr_b16 v[72:73], v50 offset:0
    ds_read_b64_tr_b16 v[74:75], v50 offset:512
    ds_read_b64_tr_b16 v[76:77], v51 offset:0
    ds_read_b64_tr_b16 v[78:79], v51 offset:512
    s_waitcnt vmcnt(12)
    ds_read_b64_tr_b16 v[80:81], v48 offset:4096
    ds_read_b64_tr_b16 v[82:83], v48 offset:4608
    ds_read_b64_tr_b16 v[84:85], v49 offset:4096
    ds_read_b64_tr_b16 v[86:87], v49 offset:4608
    ds_read_b64_tr_b16 v[88:89], v50 offset:4096
    ds_read_b64_tr_b16 v[90:91], v50 offset:4608
    ds_read_b64_tr_b16 v[92:93], v51 offset:4096
    ds_read_b64_tr_b16 v[94:95], v51 offset:4608
    s_waitcnt lgkmcnt(8)
    v_mfma_f32_16x16x32_bf16 v[96:99], v[64:67], v[20:23], 0
    v_mfma_f32_16x16x32_bf16 v[100:103], v[68:71], v[20:23], 0
    v_mfma_f32_16x16x32_bf16 v[104:107], v[72:75], v[20:23], 0
    v_mfma_f32_16x16x32_bf16 v[108:111], v[76:79], v[20:23], 0
    s_waitcnt vmcnt(8)
    ds_read_b64_tr_b16 v[64:65], v48 offset:8192
    ds_read_b64_tr_b16 v[66:67], v48 offset:8704
    ds_read_b64_tr_b16 v[68:69], v49 offset:8192
    ds_read_b64_tr_b16 v[70:71], v49 offset:8704
    ds_read_b64_tr_b16 v[72:73], v50 offset:8192
    ds_read_b64_tr_b16 v[74:75], v50 offset:8704
    ds_read_b64_tr_b16 v[76:77], v51 offset:8192
    ds_read_b64_tr_b16 v[78:79], v51 offset:8704
    s_waitcnt lgkmcnt(8)
    v_mfma_f32_16x16x32_bf16 v[96:99], v[80:83], v[24:27], v[96:99]
    v_mfma_f32_16x16x32_bf16 v[100:103], v[84:87], v[24:27], v[100:103]
    v_mfma_f32_16x16x32_bf16 v[104:107], v[88:91], v[24:27], v[104:107]
    v_mfma_f32_16x16x32_bf16 v[108:111], v[92:95], v[24:27], v[108:111]
    s_waitcnt vmcnt(4)
    ds_read_b64_tr_b16 v[80:81], v48 offset:12288
    ds_read_b64_tr_b16 v[82:83], v48 offset:12800
    ds_read_b64_tr_b16 v[84:85], v49 offset:12288
    ds_read_b64_tr_b16 v[86:87], v49 offset:12800
    ds_read_b64_tr_b16 v[88:89], v50 offset:12288
    ds_read_b64_tr_b16 v[90:91], v50 offset:12800
    ds_read_b64_tr_b16 v[92:93], v51 offset:12288
    ds_read_b64_tr_b16 v[94:95], v51 offset:12800
    s_waitcnt lgkmcnt(8)
    v_mfma_f32_16x16x32_bf16 v[96:99], v[64:67], v[28:31], v[96:99]
    v_mfma_f32_16x16x32_bf16 v[100:103], v[68:71], v[28:31], v[100:103]
    v_mfma_f32_16x16x32_bf16 v[104:107], v[72:75], v[28:31], v[104:107]
    v_mfma_f32_16x16x32_bf16 v[108:111], v[76:79], v[28:31], v[108:111]
    s_waitcnt lgkmcnt(0)
    v_mfma_f32_16x16x32_bf16 v[96:99], v[80:83], v[32:35], v[96:99]
    v_mfma_f32_16x16x32_bf16 v[100:103], v[84:87], v[32:35], v[100:103]
    v_mfma_f32_16x16x32_bf16 v[104:107], v[88:91], v[32:35], v[104:107]
    v_mfma_f32_16x16x32_bf16 v[108:111], v[92:95], v[32:35], v[108:111]
    s_mov_b32 s62, 0x22222222
    s_mov_b32 s63, 0x22222222
    s_lshl_b64 s[64:65], s[62:63], 1
    s_lshl_b64 s[66:67], s[62:63], 2
    s_getreg_b32 s77, hwreg(HW_REG_XCC_ID, 0, 4)
    s_add_u32 s77, s77, 1
    s_lshl_b32 s77, s77, 24
    s_add_u32 s77, s77, s60
    v_mov_b32 v5, s77
    v_mov_b32 v9, s60
    s_mov_b32 s68, 0x3020104
    s_mov_b32 s69, 0x3020105
    s_mov_b32 s70, 0x3020106
    s_mov_b32 s71, 0x3020107
    v_cndmask_b32 v20, v96, v100, s[62:63]
    v_cndmask_b32 v21, v97, v101, s[62:63]
    v_cndmask_b32 v22, v98, v102, s[62:63]
    v_cndmask_b32 v23, v99, v103, s[62:63]
    v_cndmask_b32 v20, v20, v104, s[64:65]
    v_cndmask_b32 v21, v21, v105, s[64:65]
    v_cndmask_b32 v22, v22, v106, s[64:65]
    v_cndmask_b32 v23, v23, v107, s[64:65]
    v_cndmask_b32 v20, v20, v108, s[66:67]
    v_cndmask_b32 v21, v21, v109, s[66:67]
    v_cndmask_b32 v22, v22, v110, s[66:67]
    v_cndmask_b32 v23, v23, v111, s[66:67]
    v_perm_b32 v60, v5, v20, s68
    v_perm_b32 v61, v5, v21, s69
    v_perm_b32 v62, v5, v22, s70
    v_perm_b32 v63, v5, v23, s71
    s_mov_b64 exec, s[74:75]
    s_waitcnt vmcnt(0)
    buffer_store_dwordx4 v[60:63], v11, s[36:39], s76 offen
L_svc_d:
    s_mov_b64 exec, -1
    v_lshlrev_b32 v8, 4, v0
    s_lshl_b32 s35, s29, 1
    s_add_u32 s35, s35, s31
    s_lshl_b32 s56, s31, 18
    s_lshl_b32 s57, s29, 14
    s_add_u32 s56, s56, s57
    s_lshl_b32 s57, s32, 2
    s_add_u32 s56, s56, s57
    s_add_u32 s56, s56, 0x101400
    s_lshl_b32 s52, s35, 13
    s_add_u32 s52, s52, 0x60000
    s_add_u32 s53, s52, 4096
    s_mov_b32 s3, 0
    s_bfe_u32 s65, s60, 0x80008
    s_bfe_u32 s66, s60, 0x80010
    s_and_b32 s64, s60, 0xff
    s_lshr_b32 s62, s77, 24
    s_lshr_b32 s63, s60, 24
    v_lshlrev_b32 v10, 7, v2
    v_and_b32 v4, 3, v0
    v_lshl_add_u32 v10, v4, 5, v10
    v_bfe_u32 v4, v0, 2, 2
    v_lshl_add_u32 v10, v4, 3, v10
    v_add_u32 v10, 147456, v10
    v_mov_b32 v5, 148736
    s_mov_b64 s[78:79], -1
    s_mov_b32 s54, s52
    s_mov_b32 s57, s53
    s_mov_b32 s72, s62
    s_mov_b32 s59, 1
    buffer_load_dwordx4 v[20:23], v8, s[36:39], s52 offen offset:0 sc1
    buffer_load_dwordx4 v[24:27], v8, s[36:39], s52 offen offset:1024 sc1
    buffer_load_dwordx4 v[28:31], v8, s[36:39], s52 offen offset:2048 sc1
    buffer_load_dwordx4 v[32:35], v8, s[36:39], s52 offen offset:3072 sc1
    buffer_load_dwordx4 v[36:39], v8, s[36:39], s53 offen offset:0 sc1
    buffer_load_dwordx4 v[40:43], v8, s[36:39], s53 offen offset:1024 sc1
    buffer_load_dwordx4 v[44:47], v8, s[36:39], s53 offen offset:2048 sc1
    buffer_load_dwordx4 v[48:51], v8, s[36:39], s53 offen offset:3072 sc1
    v_not_b32 v64, s64
    s_waitcnt vmcnt(0)
    s_branch L_b_g
.rept 288
    s_endpgm
.endr
.p2alignl 11, 0xbf810000
L_t_g:
    s_branch L_att
L_b_g:
L_qg:
    s_add_u32 s3, s3, 1
    s_cmp_gt_u32 s3, 20000
    s_cbranch_scc1 L_qgx
    s_waitcnt vmcnt(8)
    v_xor_b32 v20, s64, v20
    v_xor_b32 v21, s65, v21
    v_xor_b32 v22, s66, v22
    v_xor_b32 v23, s62, v23
    v_xor_b32 v24, s64, v24
    v_xor_b32 v25, s65, v25
    v_xor_b32 v26, s66, v26
    v_xor_b32 v27, s62, v27
    v_xor_b32 v28, s64, v28
    v_xor_b32 v29, s65, v29
    v_xor_b32 v30, s66, v30
    v_xor_b32 v31, s62, v31
    v_xor_b32 v32, s64, v32
    v_xor_b32 v33, s65, v33
    v_xor_b32 v34, s66, v34
    v_xor_b32 v35, s62, v35
    v_xor_b32 v36, s64, v36
    v_xor_b32 v37, s65, v37
    v_xor_b32 v38, s66, v38
    v_xor_b32 v39, s62, v39
    v_xor_b32 v40, s64, v40
    v_xor_b32 v41, s65, v41
    v_xor_b32 v42, s66, v42
    v_xor_b32 v43, s62, v43
    v_xor_b32 v44, s64, v44
    v_xor_b32 v45, s65, v45
    v_xor_b32 v46, s66, v46
    v_xor_b32 v47, s62, v47
    v_xor_b32 v48, s64, v48
    v_xor_b32 v49, s65, v49
    v_xor_b32 v50, s66, v50
    v_xor_b32 v51, s62, v51
    v_or_b32 v52, v20, v21
    v_or_b32 v53, v22, v23
    v_or3_b32 v52, v52, v24, v25
    v_or3_b32 v53, v53, v26, v27
    v_or3_b32 v52, v52, v28, v29
    v_or3_b32 v53, v53, v30, v31
    v_or3_b32 v52, v52, v32, v33
    v_or3_b32 v53, v53, v34, v35
    v_or3_b32 v52, v52, v36, v37
    v_or3_b32 v53, v53, v38, v39
    v_or3_b32 v52, v52, v40, v41
    v_or3_b32 v53, v53, v42, v43
    v_or3_b32 v52, v52, v44, v45
    v_or3_b32 v53, v53, v46, v47
    v_or3_b32 v52, v52, v48, v49
    v_or3_b32 v53, v53, v50, v51
    v_or_b32 v52, v52, v53
    v_and_b32 v52, 0xff, v52
    v_cmp_ne_u32 vcc, 0, v52
    s_andn2_b64 exec, s[78:79], vcc
    s_mov_b64 s[78:79], vcc
    s_cbranch_execz L_qn_4
    v_pk_add_f32 v[20:21], v[20:21], v[28:29]
    v_pk_add_f32 v[36:37], v[36:37], v[44:45]
    v_pk_add_f32 v[22:23], v[22:23], v[30:31]
    v_pk_add_f32 v[38:39], v[38:39], v[46:47]
    v_pk_add_f32 v[24:25], v[24:25], v[32:33]
    v_pk_add_f32 v[40:41], v[40:41], v[48:49]
    v_pk_add_f32 v[26:27], v[26:27], v[34:35]
    v_pk_add_f32 v[42:43], v[42:43], v[50:51]
    v_pk_add_f32 v[20:21], v[20:21], v[36:37]
    v_pk_add_f32 v[22:23], v[22:23], v[38:39]
    v_pk_add_f32 v[24:25], v[24:25], v[40:41]
    v_pk_add_f32 v[26:27], v[26:27], v[42:43]
    v_cvt_pk_bf16_f32 v56, v20, v21
    v_cvt_pk_bf16_f32 v57, v22, v23
    v_cvt_pk_bf16_f32 v58, v24, v25
    v_cvt_pk_bf16_f32 v59, v26, v27
    ds_write_b64 v10, v[56:57]
    ds_write_b64 v10, v[58:59] offset:512
L_qn_4:
    s_mov_b64 exec, s[78:79]
    s_cbranch_execz L_qgx
    buffer_load_dwordx4 v[20:23], v8, s[36:39], s52 offen offset:0 sc1
    buffer_load_dwordx4 v[24:27], v8, s[36:39], s52 offen offset:1024 sc1
    buffer_load_dwordx4 v[28:31], v8, s[36:39], s52 offen offset:2048 sc1
    buffer_load_dwordx4 v[32:35], v8, s[36:39], s52 offen offset:3072 sc1
    buffer_load_dwordx4 v[36:39], v8, s[36:39], s53 offen offset:0 sc1
    buffer_load_dwordx4 v[40:43], v8, s[36:39], s53 offen offset:1024 sc1
    buffer_load_dwordx4 v[44:47], v8, s[36:39], s53 offen offset:2048 sc1
    buffer_load_dwordx4 v[48:51], v8, s[36:39], s53 offen offset:3072 sc1
    s_waitcnt vmcnt(8)
    v_xor_b32 v64, s64, v64
    v_xor_b32 v65, s65, v65
    v_xor_b32 v66, s66, v66
    v_xor_b32 v67, s72, v67
    v_xor_b32 v68, s64, v68
    v_xor_b32 v69, s65, v69
    v_xor_b32 v70, s66, v70
    v_xor_b32 v71, s72, v71
    v_xor_b32 v72, s64, v72
    v_xor_b32 v73, s65, v73
    v_xor_b32 v74, s66, v74
    v_xor_b32 v75, s72, v75
    v_xor_b32 v76, s64, v76
    v_xor_b32 v77, s65, v77
    v_xor_b32 v78, s66, v78
    v_xor_b32 v79, s72, v79
    v_xor_b32 v80, s64, v80
    v_xor_b32 v81, s65, v81
    v_xor_b32 v82, s66, v82
    v_xor_b32 v83, s72, v83
    v_xor_b32 v84, s64, v84
    v_xor_b32 v85, s65, v85
    v_xor_b32 v86, s66, v86
    v_xor_b32 v87, s72, v87
    v_xor_b32 v88, s64, v88
    v_xor_b32 v89, s65, v89
    v_xor_b32 v90, s66, v90
    v_xor_b32 v91, s72, v91
    v_xor_b32 v92, s64, v92
    v_xor_b32 v93, s65, v93
    v_xor_b32 v94, s66, v94
    v_xor_b32 v95, s72, v95
    v_or_b32 v52, v64, v65
    v_or_b32 v53, v66, v67
    v_or3_b32 v52, v52, v68, v69
    v_or3_b32 v53, v53, v70, v71
    v_or3_b32 v52, v52, v72, v73
    v_or3_b32 v53, v53, v74, v75
    v_or3_b32 v52, v52, v76, v77
    v_or3_b32 v53, v53, v78, v79
    v_or3_b32 v52, v52, v80, v81
    v_or3_b32 v53, v53, v82, v83
    v_or3_b32 v52, v52, v84, v85
    v_or3_b32 v53, v53, v86, v87
    v_or3_b32 v52, v52, v88, v89
    v_or3_b32 v53, v53, v90, v91
    v_or3_b32 v52, v52, v92, v93
    v_or3_b32 v53, v53, v94, v95
    v_or_b32 v52, v52, v53
    v_and_b32 v52, 0xff, v52
    v_cmp_ne_u32 vcc, 0, v52
    s_andn2_b64 exec, s[78:79], vcc
    s_mov_b64 s[78:79], vcc
    s_cbranch_execz L_qn_6
    s_cmp_eq_u32 s72, s62
    s_cselect_b32 s59, s59, 2
    v_pk_add_f32 v[64:65], v[64:65], v[72:73]
    v_pk_add_f32 v[80:81], v[80:81], v[88:89]
    v_pk_add_f32 v[66:67], v[66:67], v[74:75]
    v_pk_add_f32 v[82:83], v[82:83], v[90:91]
    v_pk_add_f32 v[68:69], v[68:69], v[76:77]
    v_pk_add_f32 v[84:85], v[84:85], v[92:93]
    v_pk_add_f32 v[70:71], v[70:71], v[78:79]
    v_pk_add_f32 v[86:87], v[86:87], v[94:95]
    v_pk_add_f32 v[64:65], v[64:65], v[80:81]
    v_pk_add_f32 v[66:67], v[66:67], v[82:83]
    v_pk_add_f32 v[68:69], v[68:69], v[84:85]
    v_pk_add_f32 v[70:71], v[70:71], v[86:87]
    v_cvt_pk_bf16_f32 v56, v64, v65
    v_cvt_pk_bf16_f32 v57, v66, v67
    v_cvt_pk_bf16_f32 v58, v68, v69
    v_cvt_pk_bf16_f32 v59, v70, v71
    ds_write_b64 v10, v[56:57]
    ds_write_b64 v10, v[58:59] offset:512
L_qn_6:
    s_mov_b64 exec, s[78:79]
    s_cbranch_execz L_qgx
    s_cmp_eq_u32 s3, 6
    s_cbranch_scc0 L_qgg_7
    s_mov_b64 exec, s[74:75]
    v_perm_b32 v63, v9, v63, s71
    buffer_store_dwordx4 v[60:63], v11, s[36:39], s55 offen sc1
    s_xor_b32 s54, s54, 0x20000
    s_xor_b32 s57, s57, 0x20000
    s_mov_b32 s72, s63
    s_mov_b64 exec, s[78:79]
L_qgg_7:
    buffer_load_dwordx4 v[64:67], v8, s[36:39], s54 offen offset:0 sc1
    buffer_load_dwordx4 v[68:71], v8, s[36:39], s54 offen offset:1024 sc1
    buffer_load_dwordx4 v[72:75], v8, s[36:39], s54 offen offset:2048 sc1
    buffer_load_dwordx4 v[76:79], v8, s[36:39], s54 offen offset:3072 sc1
    buffer_load_dwordx4 v[80:83], v8, s[36:39], s57 offen offset:0 sc1
    buffer_load_dwordx4 v[84:87], v8, s[36:39], s57 offen offset:1024 sc1
    buffer_load_dwordx4 v[88:91], v8, s[36:39], s57 offen offset:2048 sc1
    buffer_load_dwordx4 v[92:95], v8, s[36:39], s57 offen offset:3072 sc1
    s_branch L_qg
.rept 288
    s_endpgm
.endr
.p2alignl 10, 0xbf810000
L_t_q:
    s_branch L_att
L_b_q:
L_qgx:
    s_mov_b64 exec, -1
    v_mov_b32 v6, s59
    ds_write_b32 v5, v9 offset:28
    ds_write_b32 v5, v6
    s_mov_b64 exec, 1
    v_mov_b32 v7, 1
    ds_add_u32 v5, v7 offset:24
    s_mov_b64 exec, -1
    s_lshr_b32 s3, s30, 1
    s_cmp_lg_u32 s3, 11
    s_cbranch_scc1 L_qok
    s_lshl3_add_u32 s3, s31, s29
    s_lshl2_add_u32 s3, s3, 0x2080
    s_mov_b64 exec, 1
    buffer_store_dword v9, v8, s[36:39], s3 offen sc1
    s_mov_b64 exec, -1
L_qok:
    v_and_b32 v4, 3, v0
    v_lshlrev_b32 v19, 4, v4
    v_add_u32 v19, 148480, v19
    s_mov_b32 s65, 0x3fb8aa3b
    v_and_b32 v101, 1, v0
    v_lshlrev_b32 v101, 6, v101
    v_bfe_u32 v4, v0, 1, 1
    v_lshl_add_u32 v101, v4, 17, v101
    s_mov_b32 s3, 0
L_w4_8:
    ds_read_b128 v[104:107], v19 offset:64
    s_add_u32 s3, s3, 1
    s_cmp_gt_u32 s3, 160000
    s_cbranch_scc1 L_w4x_9
    s_waitcnt lgkmcnt(0)
    v_max3_u32 v4, v104, v105, v106
    v_max_u32 v4, v4, v107
    v_cmp_eq_u32 vcc, -1, v4
    s_cbranch_vccnz L_w4_8
L_w4x_9:
    s_waitcnt lgkmcnt(0)
    ds_read_b128 v[96:99], v19
    v_pk_add_f32 v[104:105], v[104:105], v[106:107]
    v_add_f32 v104, v104, v105
    v_log_f32 v104, v104
    s_waitcnt lgkmcnt(0)
    v_max3_f32 v10, v96, v97, v98
    v_max_f32 v10, v10, v99
    v_fma_f32 v100, v10, s65, v104
    s_cmp_eq_u32 s59, 1
    s_mov_b64 exec, 15
    s_cbranch_scc0 L_svc_f
    buffer_store_dword v100, v101, s[36:39], s56 offen
    s_branch L_svc_g
L_svc_f:
    buffer_store_dword v100, v101, s[36:39], s56 offen sc1
L_svc_g:
    s_mov_b64 exec, -1
    s_cmp_lt_u32 s30, 16
    s_cbranch_scc1 L_exit2
    s_lshl_b32 s57, s31, 17
    s_lshl_b32 s68, s29, 14
    s_add_u32 s68, s68, s57
    s_add_u32 s68, s68, 0x101400
    v_lshlrev_b32 v18, 2, v3
    v_and_b32 v4, 1, v2
    v_lshl_add_u32 v18, v4, 6, v18
    v_lshrrev_b32 v4, 1, v2
    v_lshl_add_u32 v18, v4, 18, v18
    v_lshlrev_b32 v19, 2, v0
    v_add_u32 v19, 148992, v19
    v_mov_b32 v6, 148820
    s_mov_b32 s3, 0
L_ls_10:
    ds_read_b32 v4, v6
    s_add_u32 s3, s3, 1
    s_cmp_gt_u32 s3, 160000
    s_cbranch_scc1 L_lsx_11
    s_waitcnt lgkmcnt(0)
    v_cmp_eq_u32 vcc, 0, v4
    s_cbranch_vccz L_lsx_11
    s_sleep 2
    s_branch L_ls_10
L_lsx_11:
    s_mov_b32 s3, 0
L_wl:
    s_add_u32 s3, s3, 1
    s_cmp_gt_u32 s3, 20000
    s_cbranch_scc1 L_wl_x
    buffer_load_dword v20, v18, s[36:39], s68 offen sc1
    s_waitcnt vmcnt(0)
    v_cmp_eq_u32 vcc, -1, v20
    s_cbranch_vccnz L_wl
L_wl_x:
    v_max_f32_dpp v21, v20, v20 row_ror:1 row_mask:0xf bank_mask:0xf
    s_nop 1
    v_max_f32_dpp v21, v21, v21 row_ror:2 row_mask:0xf bank_mask:0xf
    s_nop 1
    v_max_f32_dpp v21, v21, v21 row_ror:4 row_mask:0xf bank_mask:0xf
    s_nop 1
    v_max_f32_dpp v21, v21, v21 row_ror:8 row_mask:0xf bank_mask:0xf
    v_sub_f32 v20, v20, v21
    v_exp_f32 v20, v20
    s_nop 1
    v_add_f32_dpp v21, v20, v20 row_ror:1 row_mask:0xf bank_mask:0xf
    s_nop 1
    v_add_f32_dpp v21, v21, v21 row_ror:2 row_mask:0xf bank_mask:0xf
    s_nop 1
    v_add_f32_dpp v21, v21, v21 row_ror:4 row_mask:0xf bank_mask:0xf
    s_nop 1
    v_add_f32_dpp v21, v21, v21 row_ror:8 row_mask:0xf bank_mask:0xf
    v_rcp_f32 v21, v21
    v_mov_b32 v6, 148740
    v_mul_f32 v20, v20, v21
    ds_write_b32 v19, v20
    ds_write_b32 v6, v6
    s_endpgm
.rept 288
    s_endpgm
.endr
.p2alignl 10, 0xbf810000
L_t_r:
    s_branch L_att
L_b_r:
L_red:
    s_and_b32 s3, s2, 0xc1
    s_cmp_lg_u32 s3, 1
    s_cbranch_scc1 L_exit2
    s_lshr_b32 s52, s29, 1
    s_mov_b32 s29, s30
    s_mov_b32 s74, 0x00ff00ff
    s_mov_b32 s75, s74
    s_lshl_b32 s53, s52, 10
    s_lshl_b32 s54, s29, 7
    s_add_u32 s53, s53, s54
    s_add_u32 s53, s53, 0x17f000
    v_and_b32 v5, 7, v0
    v_lshrrev_b32 v4, 3, v0
    v_lshlrev_b32 v6, 14, v4
    v_lshl_add_u32 v6, v5, 4, v6
    s_lshl_b32 s54, s29, 3
    v_add_u32 v7, s54, v5
    v_lshrrev_b32 v11, 1, v2
    v_lshl_add_u32 v8, v11, 6, v7
    s_lshl_b32 s54, s52, 7
    v_add_u32 v8, s54, v8
    v_and_b32 v7, 1, v2
    v_lshl_add_u32 v9, v7, 9, v8
    v_lshlrev_b32 v9, 1, v9
    s_mov_b32 s56, 0
    s_mov_b32 s40, s22
    s_mov_b32 s41, s23
    s_mov_b32 s42, 0x800
    s_mov_b32 s43, 0x20000
    v_mov_b32 v13, 148780
    s_mov_b32 s3, 0
L_ls_12:
    ds_read_b32 v4, v13
    s_add_u32 s3, s3, 1
    s_cmp_gt_u32 s3, 160000
    s_cbranch_scc1 L_lsx_13
    s_waitcnt lgkmcnt(0)
    v_cmp_eq_u32 vcc, 0, v4
    s_cbranch_vccz L_lsx_13
    s_sleep 4
    s_branch L_ls_12
L_lsx_13:
    v_readfirstlane_b32 s54, v4
    s_add_u32 s53, s53, s54
    s_add_u32 s64, s53, 0
    s_add_u32 s65, s53, 131072
    s_add_u32 s66, s53, 262144
    s_add_u32 s67, s53, 393216
    s_mov_b32 vcc_lo, 0xff00ffff
    s_mov_b32 vcc_hi, 0xff00ff00
    v_cndmask_b32 v10, 2.0, v6, vcc
    s_barrier
    buffer_load_dwordx4 v[16:19], v6, s[36:39], s64 offen sc1
    buffer_load_dwordx4 v[20:23], v6, s[36:39], s65 offen sc1
    buffer_load_dwordx4 v[24:27], v6, s[36:39], s66 offen sc1
    buffer_load_dwordx4 v[28:31], v10, s[36:39], s67 offen sc1
L_rl:
    s_add_u32 s56, s56, 1
    s_cmp_gt_u32 s56, 20000
    s_cbranch_scc1 L_rx
    buffer_load_dwordx4 v[32:35], v6, s[36:39], s64 offen sc1
    buffer_load_dwordx4 v[36:39], v6, s[36:39], s65 offen sc1
    buffer_load_dwordx4 v[40:43], v6, s[36:39], s66 offen sc1
    buffer_load_dwordx4 v[44:47], v10, s[36:39], s67 offen sc1
    s_waitcnt vmcnt(6)
    v_pk_add_f32 v[48:49], v[16:17], v[20:21]
    v_pk_add_f32 v[50:51], v[18:19], v[22:23]
    s_waitcnt vmcnt(4)
    v_pk_add_f32 v[52:53], v[24:25], v[28:29]
    v_pk_add_f32 v[54:55], v[26:27], v[30:31]
    v_pk_add_f32 v[48:49], v[48:49], v[52:53]
    v_pk_add_f32 v[50:51], v[50:51], v[54:55]
    v_pk_add_f32 v[52:53], v[48:49], v[50:51]
    v_cmpx_u_f32 vcc, v52, v53
    s_cbranch_execz L_rx
    buffer_load_dwordx4 v[16:19], v6, s[36:39], s64 offen sc1
    buffer_load_dwordx4 v[20:23], v6, s[36:39], s65 offen sc1
    buffer_load_dwordx4 v[24:27], v6, s[36:39], s66 offen sc1
    buffer_load_dwordx4 v[28:31], v10, s[36:39], s67 offen sc1
    s_waitcnt vmcnt(6)
    v_pk_add_f32 v[48:49], v[32:33], v[36:37]
    v_pk_add_f32 v[50:51], v[34:35], v[38:39]
    s_waitcnt vmcnt(4)
    v_pk_add_f32 v[52:53], v[40:41], v[44:45]
    v_pk_add_f32 v[54:55], v[42:43], v[46:47]
    v_pk_add_f32 v[48:49], v[48:49], v[52:53]
    v_pk_add_f32 v[50:51], v[50:51], v[54:55]
    v_pk_add_f32 v[52:53], v[48:49], v[50:51]
    v_cmpx_u_f32 vcc, v52, v53
    s_cbranch_execnz L_rl
L_rx:
    s_mov_b64 exec, -1
    s_nop 1
    v_permlane16_swap_b32 v48, v49
    v_permlane16_swap_b32 v50, v51
    v_add_f32 v48, v48, v49
    v_add_f32 v50, v50, v51
    s_nop 1
    v_permlane32_swap_b32 v48, v50
    v_add_f32 v48, v48, v50
    s_nop 1
    v_add_f32_dpp v48, v48, v48 row_ror:8 row_mask:0xf bank_mask:0xf
    v_cvt_pk_bf16_f32 v48, v48, v48
    s_mov_b64 exec, s[74:75]
    buffer_store_short v48, v9, s[40:43], 0 offen
L_red_end:
    s_endpgm
.rept 288
    s_endpgm
.endr
.p2alignl 10, 0xbf810000
L_t_k:
    s_branch L_att
L_b_k:
L_klx:
    v_mov_b32 v4, 148760
    v_mov_b32 v5, 1
    v_and_b32 v10, 3, v0
    v_lshrrev_b32 v11, 2, v3
    v_lshl_add_u32 v12, v10, 2, v11
    v_lshlrev_b32 v12, 8, v12
    v_xor_b32 v13, v2, v10
    v_lshl_add_u32 v13, v11, 2, v13
    v_lshl_add_u32 v12, v13, 4, v12
    s_waitcnt vmcnt(3)
    s_mov_b64 exec, 1
    ds_add_u32 v4, v5
    s_mov_b64 exec, -1
    s_lshl_b32 s55, s28, 12
    v_add_u32 v112, s55, v12
    v_xor_b32 v113, 64, v112
    v_xor_b32 v114, 0x80, v112
    v_xor_b32 v115, 0xc0, v112
    v_add_u32 v116, 0x10000, v112
    v_add_u32 v117, 0x10000, v113
    v_add_u32 v118, 0x10000, v114
    v_add_u32 v119, 0x10000, v115
    v_lshlrev_b32 v9, 8, v10
    v_lshl_add_u32 v9, v2, 4, v9
    v_add_u32 v9, 147456, v9
    v_lshlrev_b32 v14, 4, v10
    v_add_u32 v14, 148480, v14
    s_lshl_b32 s68, s28, 2
    v_add_u32 v13, s68, v14
    s_lshl_b32 s68, s28, 7
    s_add_u32 s68, s68, 151552
    v_lshlrev_b32 v15, 9, v11
    v_lshl_add_u32 v15, v2, 5, v15
    v_lshl_add_u32 v15, v10, 3, v15
    v_add_u32 v15, s68, v15
    s_mov_b32 s56, 0x000f000f
    s_mov_b32 s57, 0x000f000f
    s_lshl_b64 s[58:59], s[56:57], 4
    s_lshl_b64 s[60:61], s[56:57], 8
    s_lshl_b64 s[62:63], s[56:57], 12
    s_add_u32 s3, s28, 2
    s_cmp_lt_u32 s3, s69
    s_cselect_b64 s[72:73], s[56:57], 0
    s_add_u32 s74, s69, 2
    s_mov_b32 s64, 0x3db504f3
    s_mov_b32 s65, 0x3fb8aa3b
    v_mov_b32 v8, 0xff800000
    v_mov_b32 v11, 148736
    s_waitcnt vmcnt(0)
    ds_read_b128 v[32:35], v112 offset:0
    ds_read_b128 v[36:39], v113 offset:0
    ds_read_b128 v[40:43], v114 offset:0
    ds_read_b128 v[44:47], v115 offset:0
    ds_read_b128 v[48:51], v112 offset:16384
    ds_read_b128 v[52:55], v113 offset:16384
    ds_read_b128 v[56:59], v114 offset:16384
    ds_read_b128 v[60:63], v115 offset:16384
    ds_read_b128 v[64:67], v112 offset:32768
    ds_read_b128 v[68:71], v113 offset:32768
    ds_read_b128 v[72:75], v114 offset:32768
    ds_read_b128 v[76:79], v115 offset:32768
    ds_read_b128 v[80:83], v112 offset:49152
    ds_read_b128 v[84:87], v113 offset:49152
    ds_read_b128 v[88:91], v114 offset:49152
    ds_read_b128 v[92:95], v115 offset:49152
    ds_read_b128 v[96:99], v116 offset:0
    ds_read_b128 v[100:103], v117 offset:0
    ds_read_b128 v[104:107], v118 offset:0
    ds_read_b128 v[108:111], v119 offset:0
    s_mov_b32 s3, 0
L_ls_14:
    ds_read_b32 v4, v11
    s_add_u32 s3, s3, 1
    s_cmp_gt_u32 s3, 160000
    s_cbranch_scc1 L_lsx_15
    s_waitcnt lgkmcnt(0)
    v_cmp_eq_u32 vcc, 0, v4
    s_cbranch_vccz L_lsx_15
    s_sleep 1
    s_branch L_ls_14
L_lsx_15:
    ds_read_b128 v[16:19], v9 offset:0
    ds_read_b128 v[20:23], v9 offset:64
    ds_read_b128 v[24:27], v9 offset:128
    ds_read_b128 v[28:31], v9 offset:192
    s_waitcnt lgkmcnt(3)
    v_mfma_f32_16x16x32_bf16 v[112:115], v[32:35], v[16:19], 0
    v_mfma_f32_16x16x32_bf16 v[116:119], v[48:51], v[16:19], 0
    v_mfma_f32_16x16x32_bf16 v[120:123], v[64:67], v[16:19], 0
    v_mfma_f32_16x16x32_bf16 v[4:7], v[80:83], v[16:19], 0
    s_waitcnt lgkmcnt(2)
    v_mfma_f32_16x16x32_bf16 v[112:115], v[36:39], v[20:23], v[112:115]
    v_mfma_f32_16x16x32_bf16 v[116:119], v[52:55], v[20:23], v[116:119]
    v_mfma_f32_16x16x32_bf16 v[120:123], v[68:71], v[20:23], v[120:123]
    v_mfma_f32_16x16x32_bf16 v[4:7], v[84:87], v[20:23], v[4:7]
    s_waitcnt lgkmcnt(1)
    v_mfma_f32_16x16x32_bf16 v[112:115], v[40:43], v[24:27], v[112:115]
    v_mfma_f32_16x16x32_bf16 v[116:119], v[56:59], v[24:27], v[116:119]
    v_mfma_f32_16x16x32_bf16 v[120:123], v[72:75], v[24:27], v[120:123]
    v_mfma_f32_16x16x32_bf16 v[4:7], v[88:91], v[24:27], v[4:7]
    s_waitcnt lgkmcnt(0)
    v_mfma_f32_16x16x32_bf16 v[112:115], v[44:47], v[28:31], v[112:115]
    v_mfma_f32_16x16x32_bf16 v[116:119], v[60:63], v[28:31], v[116:119]
    v_mfma_f32_16x16x32_bf16 v[120:123], v[76:79], v[28:31], v[120:123]
    v_mfma_f32_16x16x32_bf16 v[4:7], v[92:95], v[28:31], v[4:7]
    v_mfma_f32_16x16x32_bf16 v[32:35], v[96:99], v[16:19], 0
    v_mfma_f32_16x16x32_bf16 v[32:35], v[100:103], v[20:23], v[32:35]
    v_mfma_f32_16x16x32_bf16 v[32:35], v[104:107], v[24:27], v[32:35]
    v_mfma_f32_16x16x32_bf16 v[32:35], v[108:111], v[28:31], v[32:35]
    s_nop 1
    v_cndmask_b32 v48, v112, v116, s[58:59]
    v_cndmask_b32 v49, v113, v117, s[58:59]
    v_cndmask_b32 v50, v114, v118, s[58:59]
    v_cndmask_b32 v51, v115, v119, s[58:59]
    v_cndmask_b32 v48, v48, v120, s[60:61]
    v_cndmask_b32 v49, v49, v121, s[60:61]
    v_cndmask_b32 v50, v50, v122, s[60:61]
    v_cndmask_b32 v51, v51, v123, s[60:61]
    v_cndmask_b32 v48, v48, v4, s[62:63]
    v_cndmask_b32 v49, v49, v5, s[62:63]
    v_cndmask_b32 v50, v50, v6, s[62:63]
    v_cndmask_b32 v51, v51, v7, s[62:63]
    v_cndmask_b32 v52, v8, v32, s[72:73]
    v_cndmask_b32 v53, v8, v33, s[72:73]
    v_cndmask_b32 v54, v8, v34, s[72:73]
    v_cndmask_b32 v55, v8, v35, s[72:73]
    s_cmp_lt_u32 s28, s74
    s_cbranch_scc1 L_b_s
    v_cndmask_b32 v48, v48, v8, s[62:63]
    v_cndmask_b32 v49, v49, v8, s[62:63]
    v_cndmask_b32 v50, v50, v8, s[62:63]
    v_cndmask_b32 v51, v51, v8, s[62:63]
    s_branch L_b_s
.rept 288
    s_endpgm
.endr
.p2alignl 10, 0xbf810000
L_t_s:
    s_branch L_att
L_b_s:
    v_cvt_pk_bf16_f32 v56, v48, v49
    v_cvt_pk_bf16_f32 v57, v50, v51
    v_cvt_pk_bf16_f32 v58, v52, v53
    v_cvt_pk_bf16_f32 v59, v54, v55
    v_lshlrev_b32 v48, 16, v56
    v_and_b32 v49, 0xffff0000, v56
    v_lshlrev_b32 v50, 16, v57
    v_and_b32 v51, 0xffff0000, v57
    v_lshlrev_b32 v52, 16, v58
    v_and_b32 v53, 0xffff0000, v58
    v_lshlrev_b32 v54, 16, v59
    v_and_b32 v55, 0xffff0000, v59
    v_mul_f32 v48, s64, v48
    v_mul_f32 v49, s64, v49
    v_mul_f32 v50, s64, v50
    v_mul_f32 v51, s64, v51
    v_mul_f32 v52, s64, v52
    v_mul_f32 v53, s64, v53
    v_mul_f32 v54, s64, v54
    v_mul_f32 v55, s64, v55
    v_cvt_pk_bf16_f32 v56, v48, v49
    v_cvt_pk_bf16_f32 v57, v50, v51
    v_cvt_pk_bf16_f32 v58, v52, v53
    v_cvt_pk_bf16_f32 v59, v54, v55
    v_lshlrev_b32 v48, 16, v56
    v_and_b32 v49, 0xffff0000, v56
    v_lshlrev_b32 v50, 16, v57
    v_and_b32 v51, 0xffff0000, v57
    v_lshlrev_b32 v52, 16, v58
    v_and_b32 v53, 0xffff0000, v58
    v_lshlrev_b32 v54, 16, v59
    v_and_b32 v55, 0xffff0000, v59
    v_max3_f32 v10, v48, v49, v50
    v_max3_f32 v11, v51, v52, v53
    v_max3_f32 v10, v10, v54, v55
    v_max_f32 v10, v10, v11
    s_nop 1
    v_max_f32_dpp v10, v10, v10 row_ror:4 row_mask:0xf bank_mask:0xf
    s_nop 1
    v_max_f32_dpp v10, v10, v10 row_ror:8 row_mask:0xf bank_mask:0xf
    v_mov_b32 v11, v10
    s_nop 1
    v_permlane16_swap_b32 v10, v11
    v_max_f32 v10, v10, v11
    v_mov_b32 v11, v10
    s_nop 1
    v_permlane32_swap_b32 v10, v11
    v_max_f32 v10, v10, v11
    ds_write_b32 v13, v10
    s_mov_b32 s3, 0
L_w4_16:
    ds_read_b128 v[16:19], v14 offset:0
    s_add_u32 s3, s3, 1
    s_cmp_gt_u32 s3, 160000
    s_cbranch_scc1 L_w4x_17
    s_waitcnt lgkmcnt(0)
    v_max3_u32 v4, v16, v17, v18
    v_max_u32 v4, v4, v19
    v_cmp_eq_u32 vcc, -1, v4
    s_cbranch_vccnz L_w4_16
L_w4x_17:
    s_waitcnt lgkmcnt(0)
    v_max3_f32 v10, v16, v17, v18
    v_max_f32 v10, v10, v19
    v_mul_f32 v10, s65, v10
    v_fma_f32 v48, v48, s65, -v10
    v_fma_f32 v49, v49, s65, -v10
    v_fma_f32 v50, v50, s65, -v10
    v_fma_f32 v51, v51, s65, -v10
    v_fma_f32 v52, v52, s65, -v10
    v_fma_f32 v53, v53, s65, -v10
    v_fma_f32 v54, v54, s65, -v10
    v_fma_f32 v55, v55, s65, -v10
    v_exp_f32 v48, v48
    v_exp_f32 v49, v49
    v_exp_f32 v50, v50
    v_exp_f32 v51, v51
    v_exp_f32 v52, v52
    v_exp_f32 v53, v53
    v_exp_f32 v54, v54
    v_exp_f32 v55, v55
    v_cvt_pk_bf16_f32 v56, v48, v49
    v_cvt_pk_bf16_f32 v57, v50, v51
    v_cvt_pk_bf16_f32 v58, v52, v53
    v_cvt_pk_bf16_f32 v59, v54, v55
    ds_write_b64 v15, v[56:57]
    s_mov_b64 exec, s[56:57]
    ds_write_b64 v15, v[58:59] offset:2048
    s_mov_b64 exec, -1
    v_pk_add_f32 v[16:17], v[48:49], v[50:51]
    v_pk_add_f32 v[18:19], v[52:53], v[54:55]
    v_pk_add_f32 v[16:17], v[16:17], v[18:19]
    v_add_f32 v11, v16, v17
    s_nop 1
    v_add_f32_dpp v11, v11, v11 row_ror:4 row_mask:0xf bank_mask:0xf
    s_nop 1
    v_add_f32_dpp v11, v11, v11 row_ror:8 row_mask:0xf bank_mask:0xf
    v_mov_b32 v12, v11
    s_nop 1
    v_permlane16_swap_b32 v11, v12
    v_add_f32 v11, v11, v12
    v_mov_b32 v12, v11
    s_nop 1
    v_permlane32_swap_b32 v11, v12
    v_add_f32 v11, v11, v12
    ds_write_b32 v13, v11 offset:64
    s_waitcnt lgkmcnt(0)
    s_cmp_lt_u32 s30, 16
    s_cbranch_scc1 L_ffn
    s_branch L_b_o
.rept 288
    s_endpgm
.endr
.p2alignl 10, 0xbf810000
L_t_o:
    s_branch L_att
L_b_o:
L_wo:
    s_and_b32 s51, s28, 3
    s_lshr_b32 s50, s28, 3
    s_mov_b32 s36, s26
    s_mov_b32 s37, s27
    s_mov_b32 s38, 0x20000000
    s_mov_b32 s39, 0x20000
    s_mov_b32 s58, s32
    s_mov_b32 s57, s31
    s_lshl_b32 s54, s51, 13
    s_add_u32 s54, s54, 81920
    v_lshrrev_b32 v4, 2, v0
    v_lshlrev_b32 v5, 7, v4
    v_bfe_u32 v4, v0, 3, 2
    v_lshl_add_u32 v5, v4, 5, v5
    v_and_b32 v6, 3, v0
    v_lshl_add_u32 v5, v6, 3, v5
    v_add_u32 v12, s54, v5
    v_xor_b32 v13, 32, v12
    v_xor_b32 v14, 64, v12
    v_xor_b32 v15, 96, v12
    s_lshr_b32 s64, s58, 1
    s_lshl_b32 s64, s64, 17
    s_lshl_b32 s59, s29, 14
    s_add_u32 s64, s64, s59
    s_and_b32 s59, s58, 1
    s_lshl2_add_u32 s59, s59, s57
    s_lshl_b32 s59, s59, 7
    s_add_u32 s64, s64, s59
    s_add_u32 s64, s64, 0x101000
    v_bfe_u32 v4, v0, 3, 1
    v_lshlrev_b32 v16, 8, v4
    v_and_b32 v4, 7, v0
    v_lshl_add_u32 v16, v4, 4, v16
    v_lshl_add_u32 v16, v2, 13, v16
    v_and_b32 v4, 1, v0
    v_mul_u32_u24 v21, 272, v4
    v_lshrrev_b32 v4, 1, v3
    v_lshl_add_u32 v21, v4, 5, v21
    v_lshrrev_b32 v4, 3, v3
    v_add_u32 v4, v4, v2
    v_lshl_add_u32 v21, v4, 3, v21
    v_add_u32 v21, 131072, v21
    v_lshlrev_b32 v17, 4, v3
    v_lshl_add_u32 v17, v2, 8, v17
    s_lshl_b32 s66, s29, 14
    s_lshl_b32 s53, s57, 17
    s_add_u32 s66, s66, s53
    s_lshr_b32 s53, s51, 1
    s_lshl_b32 s53, s53, 13
    s_add_u32 s66, s66, s53
    s_and_b32 s53, s51, 1
    s_lshl_b32 s53, s53, 11
    s_add_u32 s66, s66, s53
    s_add_u32 s66, s66, 0x100000
    s_lshl_b32 s53, s50, 18
    s_add_u32 s66, s66, s53
    s_lshr_b32 s53, s51, 1
    s_lshl1_add_u32 s53, s50, s53
    s_lshl_b32 s53, s53, 6
    s_add_u32 s53, s53, 148992
    v_lshl_add_u32 v18, v2, 4, s53
    s_lshl_b32 s53, s51, 10
    s_mul_i32 s59, s50, 272
    s_add_u32 s53, s53, s59
    s_add_u32 s53, s53, 131072
    v_lshl_add_u32 v20, v0, 2, s53
    v_lshrrev_b32 v4, 5, v0
    v_lshl_add_u32 v20, v4, 3, v20
    v_mov_b32 v7, 148744
    v_mov_b32 v6, 148740
    s_mov_b32 s53, 148736
    v_writelane_b32 v7, s53, 1
    s_branch L_b_w
.rept 288
    s_endpgm
.endr
.p2alignl 10, 0xbf810000
L_t_w:
    s_branch L_att
L_b_w:
    s_mov_b32 s3, 0
L_ls_18:
    ds_read_b32 v4, v7
    s_add_u32 s3, s3, 1
    s_cmp_gt_u32 s3, 160000
    s_cbranch_scc1 L_lsx_19
    s_waitcnt lgkmcnt(0)
    v_cmp_eq_u32 vcc, 0, v4
    s_cbranch_vccz L_lsx_19
    s_sleep 1
    s_branch L_ls_18
L_lsx_19:
    buffer_load_dwordx4 v[24:27], v17, s[36:39], s66 offen offset:0 sc1
    buffer_load_dwordx4 v[28:31], v17, s[36:39], s66 offen offset:1024 sc1
    ds_read_b64_tr_b16 v[48:49], v12 offset:0
    ds_read_b64_tr_b16 v[50:51], v12 offset:2048
    ds_read_b64_tr_b16 v[52:53], v13 offset:0
    ds_read_b64_tr_b16 v[54:55], v13 offset:2048
    ds_read_b64_tr_b16 v[56:57], v14 offset:0
    ds_read_b64_tr_b16 v[58:59], v14 offset:2048
    ds_read_b64_tr_b16 v[60:61], v15 offset:0
    ds_read_b64_tr_b16 v[62:63], v15 offset:2048
    v_mov_b32 v7, 148772
    s_mov_b32 s3, 0
L_ls_20:
    ds_read_b32 v4, v7
    s_add_u32 s3, s3, 1
    s_cmp_gt_u32 s3, 160000
    s_cbranch_scc1 L_lsx_21
    s_waitcnt lgkmcnt(0)
    v_cmp_eq_u32 vcc, 0, v4
    s_cbranch_vccz L_lsx_21
    s_branch L_ls_20
L_lsx_21:
    ds_read_b64_tr_b16 v[64:65], v12 offset:4096
    ds_read_b64_tr_b16 v[66:67], v12 offset:6144
    ds_read_b64_tr_b16 v[68:69], v13 offset:4096
    ds_read_b64_tr_b16 v[70:71], v13 offset:6144
    ds_read_b64_tr_b16 v[72:73], v14 offset:4096
    ds_read_b64_tr_b16 v[74:75], v14 offset:6144
    ds_read_b64_tr_b16 v[76:77], v15 offset:4096
    ds_read_b64_tr_b16 v[78:79], v15 offset:6144
    s_mov_b32 s3, 0
    s_branch L_wa_c
L_wa:
    s_add_u32 s3, s3, 1
    s_cmp_gt_u32 s3, 20000
    s_cbranch_scc1 L_wa_x
    s_mov_b64 exec, s[72:73]
    s_cbranch_execz L_wa1
    buffer_load_dwordx4 v[24:27], v17, s[36:39], s66 offen offset:0 sc1
    buffer_load_dwordx4 v[28:31], v17, s[36:39], s66 offen offset:1024 sc1
L_wa1:
    s_mov_b64 exec, -1
L_wa_c:
    ds_read_b32 v23, v6
    ds_read_b128 v[40:43], v18
    s_waitcnt vmcnt(0) lgkmcnt(0)
    v_max3_u32 v22, v24, v25, v26
    v_max3_u32 v19, v27, v28, v29
    v_cmp_eq_u32 vcc, 0, v23
    v_max3_u32 v22, v22, v30, v31
    v_max_u32 v22, v22, v19
    v_cmp_eq_u32 s[72:73], -1, v22
    s_or_b64 s[76:77], s[72:73], vcc
    s_cbranch_scc1 L_wa
L_wa_x:
    v_mfma_f32_16x16x32_bf16 v[80:83], v[24:27], v[48:51], 0
    v_mfma_f32_16x16x32_bf16 v[80:83], v[28:31], v[64:67], v[80:83]
    v_mfma_f32_16x16x32_bf16 v[84:87], v[24:27], v[52:55], 0
    v_mfma_f32_16x16x32_bf16 v[84:87], v[28:31], v[68:71], v[84:87]
    v_mfma_f32_16x16x32_bf16 v[88:91], v[24:27], v[56:59], 0
    v_mfma_f32_16x16x32_bf16 v[88:91], v[28:31], v[72:75], v[88:91]
    v_mfma_f32_16x16x32_bf16 v[92:95], v[24:27], v[60:63], 0
    s_nop 2
    v_mul_f32 v80, v80, v40
    v_fmac_f32 v80, v81, v41
    v_mfma_f32_16x16x32_bf16 v[92:95], v[28:31], v[76:79], v[92:95]
    v_fmac_f32 v80, v82, v42
    v_fmac_f32 v80, v83, v43
    v_mul_f32 v84, v84, v40
    v_fmac_f32 v84, v85, v41
    v_fmac_f32 v84, v86, v42
    v_fmac_f32 v84, v87, v43
    v_mul_f32 v88, v88, v40
    v_fmac_f32 v88, v89, v41
    v_permlane16_swap_b32 v80, v84
    v_fmac_f32 v88, v90, v42
    v_fmac_f32 v88, v91, v43
    v_add_f32 v80, v80, v84
    v_mul_f32 v92, v92, v40
    v_fmac_f32 v92, v93, v41
    v_fmac_f32 v92, v94, v42
    v_fmac_f32 v92, v95, v43
    s_nop 1
    v_permlane16_swap_b32 v88, v92
    v_add_f32 v88, v88, v92
    s_nop 1
    v_permlane32_swap_b32 v80, v88
    v_add_f32 v80, v80, v88
    ds_write_b32 v20, v80
    s_cmp_lg_u32 s28, 0
    s_waitcnt lgkmcnt(0)
    s_barrier
    s_cbranch_scc1 L_gend
    ds_read2st64_b64 v[32:35], v21 offset0:0 offset1:2
    ds_read2st64_b64 v[36:39], v21 offset0:4 offset1:6
    s_waitcnt lgkmcnt(1)
    v_pk_add_f32 v[32:33], v[32:33], v[34:35]
    s_waitcnt lgkmcnt(0)
    v_pk_add_f32 v[36:37], v[36:37], v[38:39]
    v_pk_add_f32 v[32:33], v[32:33], v[36:37]
    v_cvt_pk_bf16_f32 v32, v32, v33
    v_mov_b32 v33, v32
    s_nop 1
    v_permlane16_swap_b32 v32, v33
    v_mov_b32 v34, v32
    v_mov_b32 v35, v33
    s_nop 0
    v_permlane32_swap_b32 v32, v34
    v_permlane32_swap_b32 v33, v35
    s_mov_b64 exec, 0xffffffff
    buffer_store_dwordx4 v[32:35], v16, s[36:39], s64 offen sc1
    s_barrier
    s_endpgm
L_gend:
    s_endpgm
L_att:
    s_cmp_eq_u32 s28, 5
    s_cbranch_scc1 L_w5
    s_lshr_b32 s3, s30, 4
    s_add_u32 s3, s3, s28
    s_cmp_eq_u32 s3, 16
    s_cbranch_scc1 L_t_d
    s_sub_u32 s52, s28, 6
    s_lshl_b32 s55, s52, 13
    s_add_u32 s53, s34, s55
    s_add_u32 s54, s53, 4096
    s_add_u32 s33, s69, 15
    s_lshr_b32 s33, s33, 1
    s_sub_u32 s74, s33, 1
    s_cmp_ge_u32 s52, s33
    s_cbranch_scc1 L_exit2
    v_lshlrev_b32 v8, 4, v0
    v_lshlrev_b32 v124, 4, v0
    v_bfe_u32 v10, v0, 2, 2
    s_lshl_b32 s68, s52, 8
    s_add_u32 s68, s68, 151552
    v_lshlrev_b32 v9, 5, v2
    v_lshl_add_u32 v9, v10, 3, v9
    v_add_u32 v9, s68, v9
    s_mov_b32 s56, 0x11111111
    s_mov_b32 s57, 0x11111111
    s_lshl_b64 s[58:59], s[56:57], 1
    s_lshl_b64 s[60:61], s[56:57], 2
    s_lshl_b64 s[62:63], s[56:57], 3
    s_mov_b32 s66, 0x05040100
    s_mov_b32 s67, 0x07060302
    v_lshlrev_b32 v15, 4, v10
    v_add_u32 v15, 148544, v15
    v_bfe_u32 v4, v0, 2, 1
    v_lshlrev_b32 v7, 13, v4
    v_bfe_u32 v4, v0, 3, 1
    v_lshl_add_u32 v7, v4, 17, v7
    v_bfe_u32 v4, v0, 1, 1
    v_lshl_add_u32 v7, v4, 11, v7
    v_and_b32 v4, 1, v0
    v_lshl_add_u32 v7, v4, 10, v7
    v_lshl_add_u32 v7, v2, 8, v7
    s_lshl_b32 s70, s29, 14
    s_lshl_b32 s71, s31, 18
    s_add_u32 s70, s70, s71
    s_lshl_b32 s71, s32, 4
    s_add_u32 s70, s70, s71
    s_add_u32 s70, s70, 0x100000
    s_waitcnt lgkmcnt(0)
    s_mov_b32 s36, s26
    s_mov_b32 s37, s27
    s_mov_b32 s38, 0x20000000
    s_mov_b32 s39, 0x20000
    s_mov_b32 s44, s8
    s_mov_b32 s45, s9
    s_mov_b32 s46, 0x8000000
    s_mov_b32 s47, 0x20000
    s_mov_b32 s48, s8
    s_mov_b32 s49, s9
    s_mov_b32 s50, 0x8000000
    s_mov_b32 s51, 0x20000
    s_cmp_eq_u32 s52, s74
    s_cselect_b32 s68, s69, 0
    s_bitcmp1_b32 s68, 0
    s_cselect_b32 s50, 0, s50
    s_cmp_lt_u32 s30, 16
    s_cselect_b32 s72, 3, 2
    s_mov_b32 s75, s33
    s_sub_u32 s68, 5, s72
    s_min_i32 s69, s68, 1
    s_cmp_lt_u32 s52, s72
    s_cselect_b32 s68, s69, s68
    s_sub_u32 s69, s75, 1
    s_min_u32 s69, s69, s52
    s_add_u32 s68, s68, s69
    s_max_i32 s68, s68, 1
    v_mov_b32 v13, 148760
    v_mov_b32 v11, s68
    v_mov_b32 v12, 1
    s_mov_b32 s3, 0
L_ls_22:
    ds_read_b32 v4, v13
    s_add_u32 s3, s3, 1
    s_cmp_gt_u32 s3, 160000
    s_cbranch_scc1 L_lsx_23
    s_waitcnt lgkmcnt(0)
    v_cmp_lt_u32 vcc, v4, v11
    s_cbranch_vccz L_lsx_23
    s_sleep 1
    s_branch L_ls_22
L_lsx_23:
    buffer_load_dwordx4 v[32:35], v124, s[44:47], s53 offen offset:0 nt
    buffer_load_dwordx4 v[36:39], v124, s[44:47], s53 offen offset:1024 nt
    buffer_load_dwordx4 v[40:43], v124, s[44:47], s53 offen offset:2048 nt
    buffer_load_dwordx4 v[44:47], v124, s[44:47], s53 offen offset:3072 nt
    buffer_load_dwordx4 v[48:51], v124, s[48:51], s54 offen offset:0 nt
    buffer_load_dwordx4 v[52:55], v124, s[48:51], s54 offen offset:1024 nt
    buffer_load_dwordx4 v[56:59], v124, s[48:51], s54 offen offset:2048 nt
    buffer_load_dwordx4 v[60:63], v124, s[48:51], s54 offen offset:3072 nt
    s_add_u32 s68, s52, 0
    s_cmp_lg_u32 s68, s74
    s_cbranch_scc1 L_att0
    s_waitcnt vmcnt(8)
    ds_write_b32 v13, v12 offset:8
L_att0:
    s_add_u32 s69, s52, s72
    s_cmp_ge_u32 s69, s33
    s_cbranch_scc1 L_att1
    s_waitcnt vmcnt(3)
    s_mov_b64 exec, 1
    ds_add_u32 v13, v12
    s_mov_b64 exec, -1
L_att1:
    s_mov_b32 s73, 148736
    s_sub_u32 s75, s33, 3
    s_lshl_b32 s68, s52, 2
    s_add_u32 s68, s68, 148796
    v_mov_b32 v13, s68
    s_lshl_b32 s68, s52, 11
    v_add_u32 v5, s68, v8
    v_add_u32 v6, -2048, v5
    v_min_u32 v11, s75, v0
    v_lshlrev_b32 v11, 2, v11
    v_add_u32 v11, 148800, v11
    v_writelane_b32 v11, s73, 63
    v_cmp_eq_u32 vcc, 62, v0
    s_nop 1
    v_cndmask_b32 v14, v11, v13, vcc
    s_branch L_b_u
.rept 288
    s_endpgm
.endr
.p2alignl 10, 0xbf810000
L_t_u:
    s_branch L_att
L_b_u:
    ds_read_b128 v[112:115], v15
    s_mov_b32 s77, 0
    s_waitcnt lgkmcnt(0)
    v_max3_u32 v4, v112, v113, v114
    v_max_u32 v4, v4, v115
    v_cmp_eq_u32 vcc, -1, v4
    s_cbranch_vccz L_att3
    s_mov_b32 s77, 1
    s_waitcnt vmcnt(6)
    v_perm_b32 v64, v36, v32, s66
    v_perm_b32 v68, v36, v32, s67
    v_perm_b32 v72, v37, v33, s66
    v_perm_b32 v76, v37, v33, s67
    v_perm_b32 v80, v38, v34, s66
    v_perm_b32 v84, v38, v34, s67
    v_perm_b32 v88, v39, v35, s66
    v_perm_b32 v92, v39, v35, s67
    s_waitcnt vmcnt(4)
    v_perm_b32 v65, v44, v40, s66
    v_perm_b32 v69, v44, v40, s67
    v_perm_b32 v73, v45, v41, s66
    v_perm_b32 v77, v45, v41, s67
    v_perm_b32 v81, v46, v42, s66
    v_perm_b32 v85, v46, v42, s67
    v_perm_b32 v89, v47, v43, s66
    v_perm_b32 v93, v47, v43, s67
    s_waitcnt vmcnt(2)
    v_perm_b32 v66, v52, v48, s66
    v_perm_b32 v70, v52, v48, s67
    v_perm_b32 v74, v53, v49, s66
    v_perm_b32 v78, v53, v49, s67
    v_perm_b32 v82, v54, v50, s66
    v_perm_b32 v86, v54, v50, s67
    v_perm_b32 v90, v55, v51, s66
    v_perm_b32 v94, v55, v51, s67
    s_mov_b32 s3, 0
L_w4_24:
    ds_read_b128 v[112:115], v15 offset:0
    s_add_u32 s3, s3, 1
    s_cmp_gt_u32 s3, 160000
    s_cbranch_scc1 L_w4x_25
    s_waitcnt lgkmcnt(0)
    v_max3_u32 v4, v112, v113, v114
    v_max_u32 v4, v4, v115
    v_cmp_eq_u32 vcc, -1, v4
    s_cbranch_vccz L_w4x_25
    s_sleep 1
    s_branch L_w4_24
L_w4x_25:
    s_waitcnt lgkmcnt(0)
L_att3:
    ds_read_b64 v[104:105], v9
    ds_read_b64 v[106:107], v9 offset:128
    v_pk_add_f32 v[112:113], v[112:113], v[114:115]
    v_add_f32 v112, v112, v113
    v_rcp_f32 v112, v112
    v_mov_b32 v96, 0
    v_mov_b32 v97, 0
    v_mov_b32 v98, 0
    v_mov_b32 v99, 0
    v_mov_b32 v100, 0
    v_mov_b32 v101, 0
    v_mov_b32 v102, 0
    v_mov_b32 v103, 0
    s_waitcnt lgkmcnt(0)
    v_mov_b32 v113, v112
    v_cndmask_b32 v16, 0, v104, s[56:57]
    v_cndmask_b32 v17, 0, v105, s[56:57]
    v_cndmask_b32 v18, 0, v106, s[56:57]
    v_cndmask_b32 v19, 0, v107, s[56:57]
    v_cndmask_b32 v20, 0, v104, s[58:59]
    v_cndmask_b32 v21, 0, v105, s[58:59]
    v_cndmask_b32 v22, 0, v106, s[58:59]
    v_cndmask_b32 v23, 0, v107, s[58:59]
    v_cndmask_b32 v24, 0, v104, s[60:61]
    v_cndmask_b32 v25, 0, v105, s[60:61]
    v_cndmask_b32 v26, 0, v106, s[60:61]
    v_cndmask_b32 v27, 0, v107, s[60:61]
    v_cndmask_b32 v28, 0, v104, s[62:63]
    v_cndmask_b32 v29, 0, v105, s[62:63]
    v_cndmask_b32 v30, 0, v106, s[62:63]
    v_cndmask_b32 v31, 0, v107, s[62:63]
    s_cmp_lg_u32 s52, s74
    s_cbranch_scc1 L_att2
    s_cmp_eq_u32 s77, 1
    s_cbranch_scc1 L_att4
    s_mov_b32 s3, 0
L_ls_26:
    ds_read_b32 v4, v11
    s_add_u32 s3, s3, 1
    s_cmp_gt_u32 s3, 160000
    s_cbranch_scc1 L_lsx_27
    s_waitcnt lgkmcnt(0)
    v_cmp_eq_u32 vcc, 0, v4
    s_cbranch_vccz L_lsx_27
    s_branch L_ls_26
L_lsx_27:
    v_readlane_b32 s73, v4, 63
    ds_read_b128 v[104:107], v8 offset:0
    ds_read_b128 v[108:111], v8 offset:1024
    ds_read_b128 v[116:119], v8 offset:2048
    ds_read_b128 v[120:123], v8 offset:3072
    ds_read_b128 v[96:99], v8 offset:4096
    ds_read_b128 v[100:103], v8 offset:5120
    s_waitcnt lgkmcnt(2)
    v_pk_add_f32 v[104:105], v[104:105], v[116:117]
    v_pk_add_f32 v[106:107], v[106:107], v[118:119]
    v_pk_add_f32 v[108:109], v[108:109], v[120:121]
    v_pk_add_f32 v[110:111], v[110:111], v[122:123]
    ds_read_b128 v[116:119], v8 offset:6144
    ds_read_b128 v[120:123], v8 offset:7168
    s_waitcnt lgkmcnt(2)
    v_pk_add_f32 v[104:105], v[104:105], v[96:97]
    v_pk_add_f32 v[106:107], v[106:107], v[98:99]
    v_pk_add_f32 v[108:109], v[108:109], v[100:101]
    v_pk_add_f32 v[110:111], v[110:111], v[102:103]
    ds_read_b128 v[96:99], v8 offset:8192
    ds_read_b128 v[100:103], v8 offset:9216
    s_waitcnt lgkmcnt(2)
    v_pk_add_f32 v[104:105], v[104:105], v[116:117]
    v_pk_add_f32 v[106:107], v[106:107], v[118:119]
    v_pk_add_f32 v[108:109], v[108:109], v[120:121]
    v_pk_add_f32 v[110:111], v[110:111], v[122:123]
    ds_read_b128 v[116:119], v8 offset:10240
    ds_read_b128 v[120:123], v8 offset:11264
    s_waitcnt lgkmcnt(2)
    v_pk_add_f32 v[104:105], v[104:105], v[96:97]
    v_pk_add_f32 v[106:107], v[106:107], v[98:99]
    v_pk_add_f32 v[108:109], v[108:109], v[100:101]
    v_pk_add_f32 v[110:111], v[110:111], v[102:103]
    ds_read_b128 v[96:99], v8 offset:12288
    ds_read_b128 v[100:103], v8 offset:13312
    s_cmp_lt_u32 s33, 8
    s_cbranch_scc1 L_att6
    s_waitcnt lgkmcnt(2)
    v_pk_add_f32 v[104:105], v[104:105], v[116:117]
    v_pk_add_f32 v[106:107], v[106:107], v[118:119]
    v_pk_add_f32 v[108:109], v[108:109], v[120:121]
    v_pk_add_f32 v[110:111], v[110:111], v[122:123]
    s_cmp_lt_u32 s33, 9
    s_cbranch_scc1 L_att6
    s_waitcnt lgkmcnt(0)
    v_pk_add_f32 v[104:105], v[104:105], v[96:97]
    v_pk_add_f32 v[106:107], v[106:107], v[98:99]
    v_pk_add_f32 v[108:109], v[108:109], v[100:101]
    v_pk_add_f32 v[110:111], v[110:111], v[102:103]
L_att6:
    s_waitcnt lgkmcnt(0)
    v_mov_b32 v96, 0
    v_mov_b32 v97, 0
    v_mov_b32 v98, 0
    v_mov_b32 v99, 0
    v_mov_b32 v100, 0
    v_mov_b32 v101, 0
    v_mov_b32 v102, 0
    v_mov_b32 v103, 0
L_att2:
    s_branch L_b_v
.rept 288
    s_endpgm
.endr
.p2alignl 11, 0xbf810000
L_t_v:
    s_branch L_att
L_b_v:
    s_cmp_eq_u32 s77, 1
    s_cbranch_scc1 L_att4
    s_waitcnt vmcnt(6)
    v_perm_b32 v64, v36, v32, s66
    v_perm_b32 v68, v36, v32, s67
    v_perm_b32 v72, v37, v33, s66
    v_perm_b32 v76, v37, v33, s67
    v_perm_b32 v80, v38, v34, s66
    v_perm_b32 v84, v38, v34, s67
    v_perm_b32 v88, v39, v35, s66
    v_perm_b32 v92, v39, v35, s67
    s_waitcnt vmcnt(4)
    v_perm_b32 v65, v44, v40, s66
    v_perm_b32 v69, v44, v40, s67
    v_perm_b32 v73, v45, v41, s66
    v_perm_b32 v77, v45, v41, s67
    v_perm_b32 v81, v46, v42, s66
    v_perm_b32 v85, v46, v42, s67
    v_perm_b32 v89, v47, v43, s66
    v_perm_b32 v93, v47, v43, s67
    s_waitcnt vmcnt(2)
    v_perm_b32 v66, v52, v48, s66
    v_perm_b32 v70, v52, v48, s67
    v_perm_b32 v74, v53, v49, s66
    v_perm_b32 v78, v53, v49, s67
    v_perm_b32 v82, v54, v50, s66
    v_perm_b32 v86, v54, v50, s67
    v_perm_b32 v90, v55, v51, s66
    v_perm_b32 v94, v55, v51, s67
L_att4:
    s_mov_b32 s3, 0
    s_cmp_lg_u32 s52, s74
    s_waitcnt vmcnt(0)
    s_cbranch_scc1 L_att5
    ds_read_b32 v115, v13
    ds_read_b128 v[116:119], v6
    ds_read_b128 v[120:123], v6 offset:1024
L_att5:
    v_perm_b32 v67, v60, v56, s66
    v_perm_b32 v71, v60, v56, s67
    v_perm_b32 v75, v61, v57, s66
    v_perm_b32 v79, v61, v57, s67
    v_mfma_f32_16x16x32_bf16 v[96:99], v[64:67], v[16:19], v[96:99]
    v_mfma_f32_16x16x32_bf16 v[96:99], v[68:71], v[20:23], v[96:99]
    v_perm_b32 v83, v62, v58, s66
    v_perm_b32 v87, v62, v58, s67
    v_mfma_f32_16x16x32_bf16 v[96:99], v[72:75], v[24:27], v[96:99]
    v_mfma_f32_16x16x32_bf16 v[96:99], v[76:79], v[28:31], v[96:99]
    v_perm_b32 v91, v63, v59, s66
    v_perm_b32 v95, v63, v59, s67
    v_mfma_f32_16x16x32_bf16 v[100:103], v[80:83], v[16:19], v[100:103]
    v_mfma_f32_16x16x32_bf16 v[100:103], v[84:87], v[20:23], v[100:103]
    v_mfma_f32_16x16x32_bf16 v[100:103], v[88:91], v[24:27], v[100:103]
    v_mfma_f32_16x16x32_bf16 v[100:103], v[92:95], v[28:31], v[100:103]
    s_cbranch_scc0 L_att_b
    s_nop 0
    ds_write_b128 v5, v[96:99]
    s_nop 4
    ds_write_b128 v5, v[100:103] offset:1024
    ds_write_b32 v13, v12 offset:4
    s_cmp_lt_u32 s30, 16
    s_cbranch_scc1 L_exit2
    s_lshr_b32 s68, s28, 2
    s_cmp_eq_u32 s68, 2
    s_cbranch_scc1 L_wo
    s_endpgm
L_att_b:
    s_cmp_eq_u32 s77, 1
    s_cbranch_scc0 L_att_c
    s_mov_b32 s3, 0
L_ls_28:
    ds_read_b32 v4, v14
    s_add_u32 s3, s3, 1
    s_cmp_gt_u32 s3, 160000
    s_cbranch_scc1 L_lsx_29
    s_waitcnt lgkmcnt(0)
    v_cmp_eq_u32 vcc, 0, v4
    s_cbranch_vccz L_lsx_29
    s_branch L_ls_28
L_lsx_29:
    ds_read_b128 v[116:119], v6
    ds_read_b128 v[120:123], v6 offset:1024
    ds_read_b128 v[104:107], v8 offset:0
    ds_read_b128 v[108:111], v8 offset:1024
    ds_read_b128 v[32:35], v8 offset:2048
    ds_read_b128 v[36:39], v8 offset:3072
    ds_read_b128 v[40:43], v8 offset:4096
    ds_read_b128 v[44:47], v8 offset:5120
    ds_read_b128 v[48:51], v8 offset:6144
    ds_read_b128 v[52:55], v8 offset:7168
    ds_read_b128 v[56:59], v8 offset:8192
    ds_read_b128 v[60:63], v8 offset:9216
    ds_read_b128 v[64:67], v8 offset:10240
    ds_read_b128 v[68:71], v8 offset:11264
    ds_read_b128 v[72:75], v8 offset:12288
    ds_read_b128 v[76:79], v8 offset:13312
    v_readlane_b32 s73, v4, 63
    s_waitcnt lgkmcnt(14)
    v_pk_add_f32 v[96:97], v[96:97], v[116:117]
    v_pk_add_f32 v[98:99], v[98:99], v[118:119]
    v_pk_add_f32 v[100:101], v[100:101], v[120:121]
    v_pk_add_f32 v[102:103], v[102:103], v[122:123]
    s_waitcnt lgkmcnt(10)
    v_pk_add_f32 v[104:105], v[104:105], v[32:33]
    v_pk_add_f32 v[106:107], v[106:107], v[34:35]
    v_pk_add_f32 v[108:109], v[108:109], v[36:37]
    v_pk_add_f32 v[110:111], v[110:111], v[38:39]
    s_waitcnt lgkmcnt(8)
    v_pk_add_f32 v[104:105], v[104:105], v[40:41]
    v_pk_add_f32 v[106:107], v[106:107], v[42:43]
    v_pk_add_f32 v[108:109], v[108:109], v[44:45]
    v_pk_add_f32 v[110:111], v[110:111], v[46:47]
    s_waitcnt lgkmcnt(6)
    v_pk_add_f32 v[104:105], v[104:105], v[48:49]
    v_pk_add_f32 v[106:107], v[106:107], v[50:51]
    v_pk_add_f32 v[108:109], v[108:109], v[52:53]
    v_pk_add_f32 v[110:111], v[110:111], v[54:55]
    s_waitcnt lgkmcnt(4)
    v_pk_add_f32 v[104:105], v[104:105], v[56:57]
    v_pk_add_f32 v[106:107], v[106:107], v[58:59]
    v_pk_add_f32 v[108:109], v[108:109], v[60:61]
    v_pk_add_f32 v[110:111], v[110:111], v[62:63]
    s_cmp_lt_u32 s33, 8
    s_cbranch_scc1 L_att_s
    s_waitcnt lgkmcnt(2)
    v_pk_add_f32 v[104:105], v[104:105], v[64:65]
    v_pk_add_f32 v[106:107], v[106:107], v[66:67]
    v_pk_add_f32 v[108:109], v[108:109], v[68:69]
    v_pk_add_f32 v[110:111], v[110:111], v[70:71]
    s_cmp_lt_u32 s33, 9
    s_cbranch_scc1 L_att_s
    s_waitcnt lgkmcnt(0)
    v_pk_add_f32 v[104:105], v[104:105], v[72:73]
    v_pk_add_f32 v[106:107], v[106:107], v[74:75]
    v_pk_add_f32 v[108:109], v[108:109], v[76:77]
    v_pk_add_f32 v[110:111], v[110:111], v[78:79]
    s_branch L_att_s
L_att_l:
    ds_read_b32 v115, v13
    ds_read_b128 v[116:119], v6
    ds_read_b128 v[120:123], v6 offset:1024
    s_add_u32 s3, s3, 1
    s_cmp_gt_u32 s3, 160000
    s_cbranch_scc1 L_att_a
L_att_c:
    s_waitcnt lgkmcnt(2)
    v_cmp_eq_u32 vcc, 0, v115
    s_cbranch_vccnz L_att_l
L_att_a:
    s_waitcnt lgkmcnt(0)
    s_nop 0
    v_pk_add_f32 v[96:97], v[96:97], v[116:117]
    v_pk_add_f32 v[98:99], v[98:99], v[118:119]
    v_pk_add_f32 v[100:101], v[100:101], v[120:121]
    v_pk_add_f32 v[102:103], v[102:103], v[122:123]
L_att_s:
    v_pk_add_f32 v[96:97], v[96:97], v[104:105]
    v_pk_add_f32 v[98:99], v[98:99], v[106:107]
    v_pk_add_f32 v[100:101], v[100:101], v[108:109]
    v_pk_add_f32 v[102:103], v[102:103], v[110:111]
L_att_p:
    v_pk_mul_f32 v[96:97], v[96:97], v[112:113]
    v_pk_mul_f32 v[98:99], v[98:99], v[112:113]
    v_pk_mul_f32 v[100:101], v[100:101], v[112:113]
    v_pk_mul_f32 v[102:103], v[102:103], v[112:113]
    s_cmp_eq_u32 s73, 1
    v_cvt_pk_bf16_f32 v16, v96, v100
    v_cvt_pk_bf16_f32 v17, v97, v101
    v_cvt_pk_bf16_f32 v18, v98, v102
    v_cvt_pk_bf16_f32 v19, v99, v103
    s_cbranch_scc0 L_att_g
    buffer_store_dwordx4 v[16:19], v7, s[36:39], s70 offen
    s_branch L_att_h
L_att_g:
    buffer_store_dwordx4 v[16:19], v7, s[36:39], s70 offen sc1
L_att_h:
    ds_write_b32 v13, v12 offset:4
    s_endpgm
L_w5:
    s_waitcnt lgkmcnt(0)
L_w5b:
    s_cmp_lt_u32 s30, 16
    s_cbranch_scc1 L_t_f
    s_setprio 3
    v_mov_b32 v57, 1
    s_mov_b32 s58, s32
    s_mov_b32 s57, s31
    v_lshrrev_b32 v4, 3, v0
    v_and_b32 v5, 6, v4
    v_xor_b32 v5, v5, v0
    v_and_b32 v5, 7, v5
    v_lshlrev_b32 v5, 4, v5
    v_and_b32 v6, 3, v4
    v_lshl_add_u32 v8, v6, 12, v5
    v_lshrrev_b32 v6, 2, v4
    v_lshl_add_u32 v8, v6, 15, v8
    v_add_u32 v9, 64512, v8
    v_add_u32 v10, 14336, v8
    v_add_u32 v11, 78848, v8
    s_mov_b32 s44, s12
    s_mov_b32 s45, s13
    s_mov_b32 s46, 0x400000
    s_mov_b32 s47, 0x20000
    s_lshl_b32 s52, s29, 19
    s_lshl_b32 s53, s57, 18
    s_add_u32 s52, s52, s53
    s_lshl_b32 s53, s58, 7
    s_add_u32 s52, s52, s53
    s_mov_b32 m0, 81920
    v_mov_b32 v6, 148768
    s_mov_b32 s3, 0
L_ls_30:
    ds_read_b32 v4, v6
    s_add_u32 s3, s3, 1
    s_cmp_gt_u32 s3, 160000
    s_cbranch_scc1 L_lsx_31
    s_waitcnt lgkmcnt(0)
    v_cmp_eq_u32 vcc, 0, v4
    s_cbranch_vccz L_lsx_31
    s_sleep 1
    s_branch L_ls_30
L_lsx_31:
    buffer_load_dwordx4 v8, s[44:47], s52 offen offset:0 nt lds
    buffer_load_dwordx4 v9, s[44:47], s52 offen offset:1024 nt lds
    buffer_load_dwordx4 v10, s[44:47], s52 offen offset:2048 nt lds
    buffer_load_dwordx4 v11, s[44:47], s52 offen offset:3072 nt lds
    s_mov_b32 m0, 90112
    s_add_u32 s53, s52, 2048
    buffer_load_dwordx4 v8, s[44:47], s53 offen offset:0 nt lds
    buffer_load_dwordx4 v9, s[44:47], s53 offen offset:1024 nt lds
    buffer_load_dwordx4 v10, s[44:47], s53 offen offset:2048 nt lds
    buffer_load_dwordx4 v11, s[44:47], s53 offen offset:3072 nt lds
    s_mov_b32 m0, 98304
    s_add_u32 s53, s52, 131072
    buffer_load_dwordx4 v8, s[44:47], s53 offen offset:0 nt lds
    buffer_load_dwordx4 v9, s[44:47], s53 offen offset:1024 nt lds
    buffer_load_dwordx4 v10, s[44:47], s53 offen offset:2048 nt lds
    buffer_load_dwordx4 v11, s[44:47], s53 offen offset:3072 nt lds
    s_mov_b32 m0, 106496
    s_add_u32 s53, s52, 133120
    buffer_load_dwordx4 v8, s[44:47], s53 offen offset:0 nt lds
    buffer_load_dwordx4 v9, s[44:47], s53 offen offset:1024 nt lds
    buffer_load_dwordx4 v10, s[44:47], s53 offen offset:2048 nt lds
    buffer_load_dwordx4 v11, s[44:47], s53 offen offset:3072 nt lds
    s_mov_b32 m0, 86016
    s_add_u32 s53, s52, 1024
    buffer_load_dwordx4 v8, s[44:47], s53 offen offset:0 nt lds
    buffer_load_dwordx4 v9, s[44:47], s53 offen offset:1024 nt lds
    buffer_load_dwordx4 v10, s[44:47], s53 offen offset:2048 nt lds
    buffer_load_dwordx4 v11, s[44:47], s53 offen offset:3072 nt lds
    s_mov_b32 m0, 94208
    s_add_u32 s53, s52, 3072
    buffer_load_dwordx4 v8, s[44:47], s53 offen offset:0 nt lds
    buffer_load_dwordx4 v9, s[44:47], s53 offen offset:1024 nt lds
    buffer_load_dwordx4 v10, s[44:47], s53 offen offset:2048 nt lds
    buffer_load_dwordx4 v11, s[44:47], s53 offen offset:3072 nt lds
    s_mov_b32 m0, 102400
    s_add_u32 s53, s52, 132096
    buffer_load_dwordx4 v8, s[44:47], s53 offen offset:0 nt lds
    buffer_load_dwordx4 v9, s[44:47], s53 offen offset:1024 nt lds
    buffer_load_dwordx4 v10, s[44:47], s53 offen offset:2048 nt lds
    buffer_load_dwordx4 v11, s[44:47], s53 offen offset:3072 nt lds
    s_mov_b32 m0, 110592
    s_add_u32 s53, s52, 134144
    buffer_load_dwordx4 v8, s[44:47], s53 offen offset:0 nt lds
    buffer_load_dwordx4 v9, s[44:47], s53 offen offset:1024 nt lds
    buffer_load_dwordx4 v10, s[44:47], s53 offen offset:2048 nt lds
    buffer_load_dwordx4 v11, s[44:47], s53 offen offset:3072 nt lds
    v_mov_b32 v56, 148744
    s_waitcnt vmcnt(8)
    ds_write_b32 v56, v57
    s_waitcnt vmcnt(0)
    ds_write_b32 v56, v57 offset:28
    s_endpgm
L_go:
    s_getreg_b32 s56, hwreg(HW_REG_XCC_ID, 2, 1)
    s_waitcnt lgkmcnt(0)
    s_add_u32 s60, s60, 0x7f4a7c15
    s_sub_u32 s55, s66, s64
    s_cmpk_lt_u32 s55, 86
    s_addc_u32 s60, s60, s56
    s_movk_i32 s52, 0x2000
    s_bfm_b64 exec, 8, 0
    v_mov_b32 v12, s60
    v_mov_b32 v13, s60
    v_mov_b32 v14, s60
    v_mov_b32 v15, s60
    buffer_store_dwordx4 v[12:15], v16, s[36:39], s52 offen sc1
    s_mov_b64 exec, -1
    s_branch L_w5b
L_tretF:
    s_endpgm
.rept 288
    s_endpgm
.endr
.p2alignl 10, 0xbf810000
L_t_f:
    s_branch L_t_m
L_b_f:
L_ffn:
    s_bfe_u32 s57, s30, 0x20002
    s_cmp_lt_u32 s57, 2
    s_cselect_b32 s3, 1, 0
    s_xor_b32 s57, s57, s3
    s_lshl3_add_u32 s58, s57, s29
    s_sub_u32 s31, s58, 7
    s_lshr_b32 s3, s29, 1
    s_add_u32 s3, s3, 17
    s_cmp_eq_u32 s57, 3
    s_cselect_b32 s31, s3, s31
    s_mul_i32 s3, s31, 11
    s_lshr_b32 s3, s3, 5
    s_add_u32 s31, s31, s3
    s_lshl_b32 s3, s29, 2
    s_sub_u32 s3, s3, 1
    s_max_i32 s3, s3, 0
    s_cmp_eq_u32 s57, 0
    s_cselect_b32 s31, s3, s31
    s_and_b32 s3, s58, 25
    s_add_u32 s52, s58, 4
    s_cmp_eq_u32 s3, 24
    s_cselect_b32 s31, s52, s31
    s_cmp_ge_u32 s31, 28
    s_cbranch_scc1 L_exit2
    s_mov_b32 s36, s26
    s_mov_b32 s37, s27
    s_mov_b32 s38, 0x20000000
    s_mov_b32 s39, 0x20000
    s_and_b32 s62, s30, 3
    s_lshl_b32 s58, s58, 14
    v_lshlrev_b32 v10, 4, v0
    s_cmp_eq_u32 s28, 2
    s_cbranch_scc1 L_red
    s_cmp_eq_u32 s28, 3
    s_cbranch_scc1 L_res
    s_lshl1_add_u32 s63, s62, s28
    v_lshrrev_b32 v4, 3, v0
    v_and_b32 v5, 6, v4
    v_xor_b32 v5, v5, v0
    v_and_b32 v5, 7, v5
    v_lshlrev_b32 v5, 4, v5
    v_and_b32 v6, 1, v4
    v_lshrrev_b32 v4, 1, v4
    v_lshl_add_u32 v4, v4, 3, v6
    v_mul_u32_u24 v4, 3584, v4
    v_add_u32 v116, v4, v5
    v_add_u32 v117, 13312, v116
    v_add_u32 v118, 5120, v116
    v_add_u32 v119, 18432, v116
    v_and_b32 v4, 1, v0
    v_lshlrev_b32 v11, 10, v4
    v_bfe_u32 v4, v0, 1, 2
    v_lshl_add_u32 v11, v4, 4, v11
    v_lshrrev_b32 v4, 1, v2
    v_lshl_add_u32 v11, v4, 6, v11
    v_and_b32 v4, 1, v2
    v_lshl_add_u32 v11, v4, 3, v11
    s_lshl_b32 s62, s63, 7
    s_mul_i32 s52, s63, 64*3584
    s_lshl_b32 s53, s31, 7
    s_add_u32 s52, s52, s53
    s_lshl_b32 s54, s28, 14
    s_add_u32 s54, s54, 81920
    s_mov_b32 s40, s4
    s_mov_b32 s41, s5
    s_mov_b32 s42, 0x800
    s_mov_b32 s43, 0x20000
    s_mov_b32 s44, s16
    s_mov_b32 s45, s17
    s_mov_b32 s46, 0x1c0000
    s_mov_b32 s47, 0x20000
    s_mov_b32 s48, s18
    s_mov_b32 s49, s19
    s_mov_b32 s50, 0x1c0000
    s_mov_b32 s51, 0x20000
    buffer_load_dwordx2 v[124:125], v11, s[40:43], s62 offen
    v_lshrrev_b32 v4, 2, v0
    v_lshlrev_b32 v5, 7, v4
    v_bfe_u32 v4, v0, 3, 2
    v_lshl_add_u32 v5, v4, 5, v5
    v_and_b32 v6, 3, v0
    v_lshl_add_u32 v5, v6, 3, v5
    v_add_u32 v12, s54, v5
    v_xor_b32 v13, 32, v12
    v_xor_b32 v14, 64, v12
    v_xor_b32 v15, 96, v12
    s_lshr_b32 s3, s63, 2
    s_lshl_b32 s3, s3, 13
    s_add_u32 s3, s3, s58
    s_and_b32 s65, s63, 3
    s_lshl_b32 s66, s65, 9
    s_lshl1_add_u32 s64, s66, s3
    s_add_u32 s64, s64, 0x181000
    s_add_u32 s66, s66, s3
    s_add_u32 s66, s66, 0x101800
    s_add_u32 s65, s62, s58
    s_add_u32 s65, s65, 0x103400
    s_add_u32 s3, s69, 15
    s_lshr_b32 s3, s3, 1
    s_lshl2_add_u32 s3, s3, 148796
    v_mov_b32 v8, s3
    s_mov_b32 s3, 148736
    v_writelane_b32 v8, s3, 1
    s_mov_b32 s3, 0
L_ls_32:
    ds_read_b32 v9, v8
    s_add_u32 s3, s3, 1
    s_cmp_gt_u32 s3, 160000
    s_cbranch_scc1 L_lsx_33
    s_waitcnt lgkmcnt(0)
    v_cmp_eq_u32 vcc, 0, v9
    s_cbranch_vccz L_lsx_33
    s_sleep 1
    s_branch L_ls_32
L_lsx_33:
    v_readlane_b32 s78, v9, 1
    s_add_u32 m0, s54, 0
    s_nop 0
    buffer_load_dwordx4 v116, s[44:47], s52 offen offset:0 nt lds
    buffer_load_dwordx4 v117, s[44:47], s52 offen offset:1024 nt lds
    buffer_load_dwordx4 v118, s[44:47], s52 offen offset:2048 nt lds
    buffer_load_dwordx4 v119, s[44:47], s52 offen offset:3072 nt lds
    s_add_u32 m0, s54, 8192
    s_nop 0
    buffer_load_dwordx4 v116, s[48:51], s52 offen offset:0 nt lds
    buffer_load_dwordx4 v117, s[48:51], s52 offen offset:1024 nt lds
    buffer_load_dwordx4 v118, s[48:51], s52 offen offset:2048 nt lds
    buffer_load_dwordx4 v119, s[48:51], s52 offen offset:3072 nt lds
    s_add_u32 m0, s54, 4096
    s_add_u32 s52, s52, 114688
    buffer_load_dwordx4 v116, s[44:47], s52 offen offset:0 nt lds
    buffer_load_dwordx4 v117, s[44:47], s52 offen offset:1024 nt lds
    buffer_load_dwordx4 v118, s[44:47], s52 offen offset:2048 nt lds
    buffer_load_dwordx4 v119, s[44:47], s52 offen offset:3072 nt lds
    s_add_u32 m0, s54, 12288
    s_nop 0
    buffer_load_dwordx4 v116, s[48:51], s52 offen offset:0 nt lds
    buffer_load_dwordx4 v117, s[48:51], s52 offen offset:1024 nt lds
    buffer_load_dwordx4 v118, s[48:51], s52 offen offset:2048 nt lds
    buffer_load_dwordx4 v119, s[48:51], s52 offen offset:3072 nt lds
    s_branch L_b_m
.rept 288
    s_endpgm
.endr
.p2alignl 10, 0xbf810000
L_t_m:
    s_branch L_t_n
L_b_m:
    s_mov_b32 s72, 0x00ff00ff
    s_mov_b32 s73, 0x00ff00ff
    v_and_b32 v1, 2, v0
    v_mul_u32_u24 v1, 0x5555, v1
    v_add_u32 v1, 0x4444, v1
    v_lshrrev_b32 v9, 2, v3
    v_mov_b32 v20, 0x3f803f80
    v_mov_b32 v120, 0
    v_mov_b32 v16, 0
    v_mov_b32 v21, 0x3f803f80
    v_mov_b32 v121, 0
    v_mov_b32 v17, 0
    v_mov_b32 v22, 0x3f803f80
    v_mov_b32 v122, 0
    v_mov_b32 v18, 0
    v_mov_b32 v23, 0x3f803f80
    v_mov_b32 v123, 0
    v_mov_b32 v19, 0
    v_cmp_eq_u32 vcc, 0, v9
    s_nop 1
    v_cndmask_b32 v88, 0, v20, vcc
    v_cndmask_b32 v89, 0, v20, vcc
    v_cndmask_b32 v90, 0, v20, vcc
    v_cndmask_b32 v91, 0, v20, vcc
    v_cmp_eq_u32 vcc, 1, v9
    s_nop 1
    v_cndmask_b32 v92, 0, v20, vcc
    v_cndmask_b32 v93, 0, v20, vcc
    v_cndmask_b32 v94, 0, v20, vcc
    v_cndmask_b32 v95, 0, v20, vcc
    v_cmp_eq_u32 vcc, 2, v9
    s_nop 1
    v_cndmask_b32 v96, 0, v20, vcc
    v_cndmask_b32 v97, 0, v20, vcc
    v_cndmask_b32 v98, 0, v20, vcc
    v_cndmask_b32 v99, 0, v20, vcc
    v_cmp_eq_u32 vcc, 3, v9
    s_nop 1
    v_cndmask_b32 v100, 0, v20, vcc
    v_cndmask_b32 v101, 0, v20, vcc
    v_cndmask_b32 v102, 0, v20, vcc
    v_cndmask_b32 v103, 0, v20, vcc
    v_and_b32 v8, 1, v0
    v_lshlrev_b32 v8, 4, v8
    v_mov_b32 v3, 0x3f80
    v_lshlrev_b32 v8, v8, v3
    v_and_b32 v3, 2, v2
    v_xor_b32 v9, v9, v3
    v_cmp_eq_u32 vcc, 0, v9
    s_nop 1
    v_cndmask_b32 v4, 0, v8, vcc
    v_cndmask_b32 v6, 0, v8, vcc
    v_cmp_eq_u32 vcc, 1, v9
    s_nop 1
    v_cndmask_b32 v5, 0, v8, vcc
    v_cndmask_b32 v7, 0, v8, vcc
    v_mov_b32 v2, v10
    v_lshlrev_b32 v3, 3, v0
    v_mov_b32 v104, -1
    v_mov_b32 v105, -1
    v_mov_b32 v106, -1
    v_mov_b32 v107, -1
    v_mov_b32 v108, -1
    v_mov_b32 v109, -1
    v_mov_b32 v110, -1
    v_mov_b32 v111, -1
    v_mov_b32 v112, -1
    v_mov_b32 v113, -1
    v_mov_b32 v114, -1
    v_mov_b32 v115, -1
    v_mov_b32 v116, -1
    v_mov_b32 v117, -1
    v_mov_b32 v118, -1
    v_mov_b32 v119, -1
    v_lshrrev_b32 v10, 3, v0
    v_lshlrev_b32 v10, 14, v10
    v_and_b32 v8, 7, v0
    v_lshl_add_u32 v10, v8, 4, v10
    v_mov_b32 v8, 148780
    s_mov_b32 s3, 0
L_ls_34:
    ds_read_b32 v9, v8
    s_add_u32 s3, s3, 1
    s_cmp_gt_u32 s3, 160000
    s_cbranch_scc1 L_lsx_35
    s_waitcnt lgkmcnt(0)
    v_cmp_eq_u32 vcc, 0, v9
    s_cbranch_vccz L_lsx_35
    s_sleep 1
    s_branch L_ls_34
L_lsx_35:
    v_readfirstlane_b32 s53, v9
    s_lshr_b32 s52, s63, 1
    s_lshl_b32 s52, s52, 17
    s_add_u32 s52, s52, s53
    s_and_b32 s53, s63, 1
    s_lshl_b32 s53, s53, 9
    s_add_u32 s52, s52, s53
    s_add_u32 s52, s52, 0x100000
    s_mov_b32 s3, 0
    s_add_u32 s77, s62, 141312
    v_add_u32 v11, s77, v11
    s_branch L_b_n
.rept 288
    s_endpgm
.endr
.p2alignl 10, 0xbf810000
L_t_n:
    s_branch L_t_p
L_b_n:
    s_waitcnt vmcnt(12)
    ds_read_b64_tr_b16 v[24:25], v12 offset:0
    ds_read_b64_tr_b16 v[26:27], v12 offset:2048
    ds_read_b64_tr_b16 v[32:33], v13 offset:0
    ds_read_b64_tr_b16 v[34:35], v13 offset:2048
    ds_read_b64_tr_b16 v[40:41], v14 offset:0
    ds_read_b64_tr_b16 v[42:43], v14 offset:2048
    ds_read_b64_tr_b16 v[48:49], v15 offset:0
    ds_read_b64_tr_b16 v[50:51], v15 offset:2048
    v_cndmask_b32 v124, 0, v124, s[72:73]
    v_cndmask_b32 v125, 0, v125, s[72:73]
    s_cmp_eq_u32 s78, 1
    s_waitcnt vmcnt(8)
    ds_read_b64_tr_b16 v[56:57], v12 offset:8192
    ds_read_b64_tr_b16 v[58:59], v12 offset:10240
    ds_read_b64_tr_b16 v[64:65], v13 offset:8192
    ds_read_b64_tr_b16 v[66:67], v13 offset:10240
    ds_read_b64_tr_b16 v[72:73], v14 offset:8192
    ds_read_b64_tr_b16 v[74:75], v14 offset:10240
    ds_read_b64_tr_b16 v[80:81], v15 offset:8192
    ds_read_b64_tr_b16 v[82:83], v15 offset:10240
    s_waitcnt vmcnt(4)
    ds_read_b64_tr_b16 v[28:29], v12 offset:4096
    ds_read_b64_tr_b16 v[30:31], v12 offset:6144
    ds_read_b64_tr_b16 v[36:37], v13 offset:4096
    ds_read_b64_tr_b16 v[38:39], v13 offset:6144
    ds_read_b64_tr_b16 v[44:45], v14 offset:4096
    ds_read_b64_tr_b16 v[46:47], v14 offset:6144
    ds_read_b64_tr_b16 v[52:53], v15 offset:4096
    ds_read_b64_tr_b16 v[54:55], v15 offset:6144
    s_waitcnt lgkmcnt(0)
    v_smfmac_f32_16x16x64_bf16 v[16:19], v[88:91], v[24:31], v1
    v_smfmac_f32_16x16x64_bf16 v[16:19], v[92:95], v[32:39], v1
    v_smfmac_f32_16x16x64_bf16 v[16:19], v[96:99], v[40:47], v1
    v_smfmac_f32_16x16x64_bf16 v[16:19], v[100:103], v[48:55], v1
    s_waitcnt vmcnt(0)
    buffer_load_dwordx4 v[104:107], v10, s[36:39], s52 offen offset:0 sc1
    buffer_load_dwordx4 v[108:111], v10, s[36:39], s52 offen offset:256 sc1
    buffer_load_dwordx4 v[112:115], v10, s[36:39], s52 offen offset:128 sc1
    buffer_load_dwordx4 v[116:119], v10, s[36:39], s52 offen offset:384 sc1
    ds_read_b64_tr_b16 v[60:61], v12 offset:12288
    ds_read_b64_tr_b16 v[62:63], v12 offset:14336
    ds_read_b64_tr_b16 v[68:69], v13 offset:12288
    ds_read_b64_tr_b16 v[70:71], v13 offset:14336
    ds_read_b64_tr_b16 v[76:77], v14 offset:12288
    ds_read_b64_tr_b16 v[78:79], v14 offset:14336
    ds_read_b64_tr_b16 v[84:85], v15 offset:12288
    ds_read_b64_tr_b16 v[86:87], v15 offset:14336
    v_mov_b32 v12, 0
    v_mov_b32 v13, 0
    v_mov_b32 v14, 0
    v_mov_b32 v15, 0
    v_add_f32 v126, v16, v18
    s_waitcnt lgkmcnt(6)
    v_smfmac_f32_16x16x64_bf16 v[120:123], v[88:91], v[56:63], v1
    s_waitcnt lgkmcnt(4)
    v_smfmac_f32_16x16x64_bf16 v[120:123], v[92:95], v[64:71], v1
    s_waitcnt lgkmcnt(2)
    v_smfmac_f32_16x16x64_bf16 v[120:123], v[96:99], v[72:79], v1
    s_waitcnt lgkmcnt(0)
    v_smfmac_f32_16x16x64_bf16 v[120:123], v[100:103], v[80:87], v1
    s_nop 7
    v_add_f32 v127, v120, v122
    v_mov_b32 v120, 0
    v_mov_b32 v121, 0
    v_mov_b32 v122, 0
    v_mov_b32 v123, 0
    s_cbranch_scc0 L_m1
    buffer_store_dwordx2 v[126:127], v3, s[36:39], s66 offen
    s_branch L_m2
L_m1:
    buffer_store_dwordx2 v[126:127], v3, s[36:39], s66 offen sc1
L_m2:
    v_lshlrev_b32 v16, 16, v124
    v_and_b32 v17, 0xffff0000, v124
    v_lshlrev_b32 v18, 16, v125
    v_and_b32 v19, 0xffff0000, v125
    s_waitcnt vmcnt(1)
    s_nop 0
    v_smfmac_f32_16x16x64_bf16 v[16:19], v[4:7], v[104:111], v1
    v_smfmac_f32_16x16x64_bf16 v[16:19], v[4:7], v[112:119], v1
    v_max3_u32 v8, v104, v108, v112
    v_max_u32 v8, v8, v116
    v_cmp_eq_u32 s[74:75], -1, v8
    s_nop 4
    v_add_f32_dpp v16, v16, v16 row_ror:8 row_mask:0xf bank_mask:0xf
    v_add_f32_dpp v17, v17, v17 row_ror:8 row_mask:0xf bank_mask:0xf
    v_add_f32_dpp v18, v18, v18 row_ror:8 row_mask:0xf bank_mask:0xf
    v_add_f32_dpp v19, v19, v19 row_ror:8 row_mask:0xf bank_mask:0xf
    v_cvt_pk_bf16_f32 v8, v16, v17
    v_cvt_pk_bf16_f32 v9, v18, v19
    v_cmp_u_f32 vcc, v16, v18
    s_cbranch_vccz L_h2x
    s_branch L_b_p
.rept 288
    s_endpgm
.endr
.p2alignl 10, 0xbf810000
L_t_p:
    s_branch L_tretF
L_b_p:
L_h2:
    s_add_u32 s3, s3, 1
    s_cmp_gt_u32 s3, 20000
    s_cbranch_scc1 L_h2x
    s_cmp_eq_u64 s[74:75], 0
    s_cselect_b64 exec, -1, s[74:75]
    buffer_load_dwordx4 v[104:107], v10, s[36:39], s52 offen offset:0 sc1
    buffer_load_dwordx4 v[108:111], v10, s[36:39], s52 offen offset:256 sc1
    buffer_load_dwordx4 v[112:115], v10, s[36:39], s52 offen offset:128 sc1
    buffer_load_dwordx4 v[116:119], v10, s[36:39], s52 offen offset:384 sc1
    s_mov_b64 exec, -1
    v_lshlrev_b32 v16, 16, v124
    v_and_b32 v17, 0xffff0000, v124
    v_lshlrev_b32 v18, 16, v125
    v_and_b32 v19, 0xffff0000, v125
    s_waitcnt vmcnt(2)
    s_nop 0
    v_smfmac_f32_16x16x64_bf16 v[16:19], v[4:7], v[104:111], v1
    s_waitcnt vmcnt(0)
    v_smfmac_f32_16x16x64_bf16 v[16:19], v[4:7], v[112:119], v1
    v_max3_u32 v8, v104, v108, v112
    v_max_u32 v8, v8, v116
    v_cmp_eq_u32 s[74:75], -1, v8
    s_nop 4
    v_add_f32_dpp v16, v16, v16 row_ror:8 row_mask:0xf bank_mask:0xf
    v_add_f32_dpp v17, v17, v17 row_ror:8 row_mask:0xf bank_mask:0xf
    v_add_f32_dpp v18, v18, v18 row_ror:8 row_mask:0xf bank_mask:0xf
    v_add_f32_dpp v19, v19, v19 row_ror:8 row_mask:0xf bank_mask:0xf
    v_cvt_pk_bf16_f32 v8, v16, v17
    v_cvt_pk_bf16_f32 v9, v18, v19
    v_cmp_u_f32 vcc, v16, v18
    s_cbranch_vccnz L_h2
L_h2x:
    s_mov_b64 exec, -1
    s_cmp_eq_u32 s78, 1
    v_mov_b32_dpp v88, v8 quad_perm:[0,1,2,3] row_mask:0xf bank_mask:0x1
    v_mov_b32_dpp v89, v9 quad_perm:[0,1,2,3] row_mask:0xf bank_mask:0x1
    v_mov_b32_dpp v90, v8 row_ror:12 row_mask:0xf bank_mask:0x1
    v_mov_b32_dpp v91, v9 row_ror:12 row_mask:0xf bank_mask:0x1
    v_mov_b32_dpp v92, v8 row_ror:4 row_mask:0xf bank_mask:0x2
    v_mov_b32_dpp v93, v9 row_ror:4 row_mask:0xf bank_mask:0x2
    v_smfmac_f32_16x16x64_bf16 v[12:15], v[88:91], v[24:31], v1
    v_mov_b32_dpp v94, v8 quad_perm:[0,1,2,3] row_mask:0xf bank_mask:0x2
    v_mov_b32_dpp v95, v9 quad_perm:[0,1,2,3] row_mask:0xf bank_mask:0x2
    v_smfmac_f32_16x16x64_bf16 v[120:123], v[88:91], v[56:63], v1
    v_mov_b32_dpp v20, v8 quad_perm:[0,1,2,3] row_mask:0xf bank_mask:0x1
    v_mov_b32_dpp v21, v9 quad_perm:[0,1,2,3] row_mask:0xf bank_mask:0x1
    v_smfmac_f32_16x16x64_bf16 v[12:15], v[92:95], v[32:39], v1
    v_mov_b32_dpp v22, v8 row_ror:12 row_mask:0xf bank_mask:0x1
    v_mov_b32_dpp v23, v9 row_ror:12 row_mask:0xf bank_mask:0x1
    v_smfmac_f32_16x16x64_bf16 v[120:123], v[92:95], v[64:71], v1
    v_mov_b32_dpp v96, v8 row_ror:8 row_mask:0xf bank_mask:0x4
    v_mov_b32_dpp v97, v9 row_ror:8 row_mask:0xf bank_mask:0x4
    v_mfma_f32_16x16x32_bf16 v[16:19], v[88:91], v[20:23], 0
    v_mov_b32_dpp v98, v8 row_ror:4 row_mask:0xf bank_mask:0x4
    v_mov_b32_dpp v99, v9 row_ror:4 row_mask:0xf bank_mask:0x4
    v_mov_b32_dpp v100, v8 row_ror:12 row_mask:0xf bank_mask:0x8
    v_mov_b32_dpp v101, v9 row_ror:12 row_mask:0xf bank_mask:0x8
    v_smfmac_f32_16x16x64_bf16 v[12:15], v[96:99], v[40:47], v1
    v_mov_b32_dpp v102, v8 row_ror:8 row_mask:0xf bank_mask:0x8
    v_mov_b32_dpp v103, v9 row_ror:8 row_mask:0xf bank_mask:0x8
    v_smfmac_f32_16x16x64_bf16 v[120:123], v[96:99], v[72:79], v1
    ds_write_b64 v11, v[8:9]
    v_smfmac_f32_16x16x64_bf16 v[12:15], v[100:103], v[48:55], v1
    v_smfmac_f32_16x16x64_bf16 v[120:123], v[100:103], v[80:87], v1
    s_mov_b64 exec, 0xff
    s_cbranch_scc0 L_p2
    buffer_store_dwordx4 v[16:19], v2, s[36:39], s65 offen
    s_mov_b64 exec, -1
    s_nop 2
    v_pk_add_f32 v[4:5], v[12:13], v[14:15]
    v_pk_add_f32 v[6:7], v[120:121], v[122:123]
    buffer_store_dwordx4 v[4:7], v2, s[36:39], s64 offen
    s_waitcnt lgkmcnt(0)
    s_barrier
    s_endpgm
L_p2:
    buffer_store_dwordx4 v[16:19], v2, s[36:39], s65 offen sc1
    s_mov_b64 exec, -1
    s_nop 7
    v_pk_add_f32 v[4:5], v[12:13], v[14:15]
    v_pk_add_f32 v[6:7], v[120:121], v[122:123]
    buffer_store_dwordx4 v[4:7], v2, s[36:39], s64 offen sc1
    s_waitcnt lgkmcnt(0)
    s_barrier
    s_endpgm
L_res:
    v_mov_b32 v8, 148764
    ds_read_b32 v12, v8
    s_waitcnt lgkmcnt(0)
    v_readfirstlane_b32 s60, v12
    v_lshlrev_b32 v8, 2, v0
    v_cmp_gt_u32 vcc, 16, v0
    v_add_u32 v8, 128, v8
    s_nop 0
    v_cndmask_b32 v8, 0, v8, vcc
    s_mov_b32 s3, 0
    s_movk_i32 s80, 0x2000
L_af_36:
    buffer_load_dword v9, v8, s[36:39], s80 offen sc1
    s_add_u32 s3, s3, 1
    s_cmp_gt_u32 s3, 20000
    s_waitcnt vmcnt(0)
    s_cbranch_scc1 L_afx_37
    v_cmp_ne_u32 vcc, s60, v9
    s_lshr_b32 s81, vcc_lo, 8
    s_and_b32 s81, s81, vcc_lo
    s_and_b32 s81, s81, 0xff
    s_cbranch_scc0 L_afx_37
    s_sleep 4
    s_branch L_af_36
L_afx_37:
    v_readlane_b32 s55, v9, 16
    s_sub_u32 s55, s55, s60
    s_cmp_le_u32 s55, 2
    s_cselect_b32 s55, s55, 0
    s_getreg_b32 s53, hwreg(HW_REG_XCC_ID, 2, 1)
    s_xor_b32 s53, s53, s55
    s_and_b32 s53, s53, 1
    s_lshl_b32 s53, s53, 13
    s_addk_i32 s53, 0x1000
    v_mov_b32 v8, 148780
    v_mov_b32 v9, s53
    ds_write_b32 v8, v9
    s_cmp_lg_u32 s2, 1
    s_cbranch_scc1 L_res1
    v_mov_b32 v13, v12
    v_mov_b32 v14, v12
    v_mov_b32 v15, v12
    s_mov_b64 exec, 0xff
    buffer_store_dwordx4 v[12:15], v10, s[36:39], 0 offen sc1
    s_mov_b64 exec, -1
L_res1:
    s_cmp_lg_u32 s31, 0
    s_cbranch_scc1 L_exit2
    s_lshl_b32 s54, s62, 10
    s_add_u32 s76, s54, 0x1e0000
    s_add_u32 s77, s76, 0x2000
    s_lshl_b32 s53, s62, 8
    s_add_u32 s53, s53, 141312
    v_lshl_add_u32 v22, v0, 1, s53
    s_barrier
    ds_read_u16 v16, v22 offset:0
    ds_read_u16 v17, v22 offset:1024
    ds_read_u16 v18, v22 offset:128
    ds_read_u16 v19, v22 offset:1152
    s_waitcnt lgkmcnt(0)
    v_lshlrev_b32 v16, 16, v16
    v_lshlrev_b32 v17, 16, v17
    v_lshlrev_b32 v18, 16, v18
    v_lshlrev_b32 v19, 16, v19
    buffer_store_dwordx4 v[16:19], v10, s[36:39], s76 offen sc1
    buffer_store_dwordx4 v[16:19], v10, s[36:39], s77 offen sc1
    s_endpgm
.rept 288
    s_endpgm
.endr
.p2alignl 11, 0xbf810000
L_tretA:
    s_waitcnt lgkmcnt(0)
    s_bfe_u32 s57, s30, 0x20002
    s_cmp_lt_u32 s57, 2
    s_cselect_b32 s3, 1, 0
    s_xor_b32 s57, s57, s3
    s_lshl3_add_u32 s58, s57, s29
    s_sub_u32 s31, s58, 7
    s_lshr_b32 s3, s29, 1
    s_add_u32 s3, s3, 17
    s_cmp_eq_u32 s57, 3
    s_cselect_b32 s31, s3, s31
    s_mul_i32 s3, s31, 11
    s_lshr_b32 s3, s3, 5
    s_add_u32 s31, s31, s3
    s_lshl_b32 s3, s29, 2
    s_sub_u32 s3, s3, 1
    s_max_i32 s3, s3, 0
    s_cmp_eq_u32 s57, 0
    s_cselect_b32 s31, s3, s31
    s_and_b32 s3, s58, 25
    s_add_u32 s52, s58, 4
    s_cmp_eq_u32 s3, 24
    s_cselect_b32 s31, s52, s31
    s_cmp_ge_u32 s31, 28
    s_cbranch_scc1 L_exit2
    s_mov_b32 s36, s26
    s_mov_b32 s37, s27
    s_mov_b32 s38, 0x20000000
    s_mov_b32 s39, 0x20000
    s_and_b32 s62, s30, 3
    s_lshl_b32 s58, s58, 14
    v_lshlrev_b32 v10, 4, v0
    s_lshl_b32 s76, s62, 10
    s_add_u32 s76, s76, s58
    s_add_u32 s76, s76, 0x180000
    s_add_u32 s77, s76, 0x2000
    s_add_u32 s70, s58, 0x181000
    s_add_u32 s71, s70, 0x2000
    s_add_u32 s72, s58, 0x101800
    s_add_u32 s73, s72, 0x2000
    s_add_u32 s74, s58, 0x103400
    s_lshl_b32 s52, s31, 16
    s_lshl_b32 s53, s62, 8
    s_add_u32 s52, s52, s53
    s_add_u32 s53, s52, 128
    s_add_u32 s54, s52, 0x8000
    s_add_u32 s55, s53, 0x8000
    v_lshrrev_b32 v4, 3, v0
    v_and_b32 v5, 6, v4
    v_xor_b32 v5, v5, v0
    v_and_b32 v5, 7, v5
    v_lshlrev_b32 v5, 4, v5
    v_and_b32 v6, 4, v4
    v_add_u32 v4, v4, v6
    v_lshl_add_u32 v24, v4, 10, v5
    v_add_u32 v25, 15360, v24
    v_add_u32 v26, 2048, v24
    v_add_u32 v27, 17408, v24
    v_lshrrev_b32 v4, 2, v0
    v_lshlrev_b32 v5, 7, v4
    v_bfe_u32 v4, v0, 3, 2
    v_lshl_add_u32 v5, v4, 5, v5
    v_and_b32 v6, 3, v0
    v_lshl_add_u32 v5, v6, 3, v5
    v_add_u32 v120, 114688, v5
    v_xor_b32 v121, 32, v120
    v_xor_b32 v122, 64, v120
    v_xor_b32 v123, 96, v120
    v_mov_b32 v22, v10
    s_mov_b32 s40, s20
    s_mov_b32 s41, s21
    s_mov_b32 s42, 0x1c0000
    s_mov_b32 s43, 0x20000
    v_lshlrev_b32 v126, 3, v0
    v_bfe_u32 v13, v0, 3, 1
    v_and_b32 v12, 7, v0
    v_lshlrev_b32 v21, 7, v12
    v_and_b32 v12, 1, v2
    v_lshl_add_u32 v12, v12, 1, v13
    v_mul_u32_u24 v13, 20, v12
    v_lshl_add_u32 v12, v12, 2, 64
    v_cmp_gt_u32 vcc, 32, v0
    s_nop 1
    v_cndmask_b32 v12, v12, v13, vcc
    v_add_u32 v21, v21, v12
    v_and_b32 v1, 2, v0
    v_mul_u32_u24 v1, 0x5555, v1
    v_add_u32 v1, 0x4444, v1
    v_mov_b32 v2, 0
    s_mov_b32 s56, 0xfff0fff0
    s_mov_b32 s57, s56
    s_mov_b32 s58, 0xff0fff0f
    s_mov_b32 s59, s58
    s_mov_b32 s60, 0xf0fff0ff
    s_mov_b32 s61, s60
    s_mov_b32 s62, 0x0fff0fff
    s_mov_b32 s63, s62
    s_mov_b32 m0, 114688
    s_mov_b32 s3, 0
    s_barrier
    buffer_load_dwordx4 v24, s[40:43], s52 offen offset:0 nt lds
    buffer_load_dwordx4 v25, s[40:43], s52 offen offset:1024 nt lds
    buffer_load_dwordx4 v26, s[40:43], s52 offen offset:2048 nt lds
    buffer_load_dwordx4 v27, s[40:43], s52 offen offset:3072 nt lds
    s_barrier
    s_mov_b32 m0, 122880
    s_nop 0
    buffer_load_dwordx4 v24, s[40:43], s53 offen offset:0 nt lds
    buffer_load_dwordx4 v25, s[40:43], s53 offen offset:1024 nt lds
    buffer_load_dwordx4 v26, s[40:43], s53 offen offset:2048 nt lds
    buffer_load_dwordx4 v27, s[40:43], s53 offen offset:3072 nt lds
    s_mov_b32 m0, 118784
    s_nop 0
    buffer_load_dwordx4 v24, s[40:43], s54 offen offset:0 nt lds
    buffer_load_dwordx4 v25, s[40:43], s54 offen offset:1024 nt lds
    buffer_load_dwordx4 v26, s[40:43], s54 offen offset:2048 nt lds
    buffer_load_dwordx4 v27, s[40:43], s54 offen offset:3072 nt lds
    s_mov_b32 m0, 126976
    s_nop 0
    buffer_load_dwordx4 v24, s[40:43], s55 offen offset:0 nt lds
    buffer_load_dwordx4 v25, s[40:43], s55 offen offset:1024 nt lds
    buffer_load_dwordx4 v26, s[40:43], s55 offen offset:2048 nt lds
    buffer_load_dwordx4 v27, s[40:43], s55 offen offset:3072 nt lds
    buffer_load_dwordx2 v[4:5], v126, s[36:39], s72 offen offset:0 sc1
    buffer_load_dwordx2 v[6:7], v126, s[36:39], s72 offen offset:512 sc1
    buffer_load_dwordx2 v[8:9], v126, s[36:39], s72 offen offset:1024 sc1
    buffer_load_dwordx2 v[10:11], v126, s[36:39], s72 offen offset:1536 sc1
    buffer_load_dwordx2 v[12:13], v126, s[36:39], s73 offen offset:0 sc1
    buffer_load_dwordx2 v[14:15], v126, s[36:39], s73 offen offset:512 sc1
    buffer_load_dwordx2 v[16:17], v126, s[36:39], s73 offen offset:1024 sc1
    buffer_load_dwordx2 v[18:19], v126, s[36:39], s73 offen offset:1536 sc1
    s_waitcnt vmcnt(20)
    ds_read_b64_tr_b16 v[56:57], v120 offset:0
    ds_read_b64_tr_b16 v[58:59], v120 offset:2048
    ds_read_b64_tr_b16 v[64:65], v121 offset:0
    ds_read_b64_tr_b16 v[66:67], v121 offset:2048
    ds_read_b64_tr_b16 v[72:73], v122 offset:0
    ds_read_b64_tr_b16 v[74:75], v122 offset:2048
    ds_read_b64_tr_b16 v[80:81], v123 offset:0
    ds_read_b64_tr_b16 v[82:83], v123 offset:2048
    s_waitcnt vmcnt(16)
    ds_read_b64_tr_b16 v[88:89], v120 offset:8192
    ds_read_b64_tr_b16 v[90:91], v120 offset:10240
    ds_read_b64_tr_b16 v[96:97], v121 offset:8192
    ds_read_b64_tr_b16 v[98:99], v121 offset:10240
    ds_read_b64_tr_b16 v[104:105], v122 offset:8192
    ds_read_b64_tr_b16 v[106:107], v122 offset:10240
    ds_read_b64_tr_b16 v[112:113], v123 offset:8192
    ds_read_b64_tr_b16 v[114:115], v123 offset:10240
    s_waitcnt vmcnt(12)
    ds_read_b64_tr_b16 v[60:61], v120 offset:4096
    ds_read_b64_tr_b16 v[62:63], v120 offset:6144
    ds_read_b64_tr_b16 v[68:69], v121 offset:4096
    ds_read_b64_tr_b16 v[70:71], v121 offset:6144
    ds_read_b64_tr_b16 v[76:77], v122 offset:4096
    ds_read_b64_tr_b16 v[78:79], v122 offset:6144
    ds_read_b64_tr_b16 v[84:85], v123 offset:4096
    ds_read_b64_tr_b16 v[86:87], v123 offset:6144
    s_waitcnt vmcnt(8)
    buffer_load_dword v23, v21, s[36:39], s74 offen sc1
    buffer_load_dwordx4 v[24:27], v22, s[36:39], s70 offen offset:0 sc1
    buffer_load_dwordx4 v[28:31], v22, s[36:39], s70 offen offset:1024 sc1
    buffer_load_dwordx4 v[32:35], v22, s[36:39], s70 offen offset:2048 sc1
    buffer_load_dwordx4 v[36:39], v22, s[36:39], s70 offen offset:3072 sc1
    buffer_load_dwordx4 v[40:43], v22, s[36:39], s71 offen offset:0 sc1
    buffer_load_dwordx4 v[44:47], v22, s[36:39], s71 offen offset:1024 sc1
    buffer_load_dwordx4 v[48:51], v22, s[36:39], s71 offen offset:2048 sc1
    buffer_load_dwordx4 v[52:55], v22, s[36:39], s71 offen offset:3072 sc1
    ds_read_b64_tr_b16 v[92:93], v120 offset:12288
    ds_read_b64_tr_b16 v[94:95], v120 offset:14336
    ds_read_b64_tr_b16 v[100:101], v121 offset:12288
    ds_read_b64_tr_b16 v[102:103], v121 offset:14336
    ds_read_b64_tr_b16 v[108:109], v122 offset:12288
    ds_read_b64_tr_b16 v[110:111], v122 offset:14336
    ds_read_b64_tr_b16 v[116:117], v123 offset:12288
    ds_read_b64_tr_b16 v[118:119], v123 offset:14336
    s_waitcnt vmcnt(9)
    s_branch L_b_d
.rept 288
    s_endpgm
.endr
.p2alignl 11, 0xbf810000
L_t_d:
    s_branch L_tretA
L_b_d:
L_cs:
    v_pk_add_f32 v[4:5], v[4:5], v[6:7]
    v_pk_add_f32 v[4:5], v[4:5], v[8:9]
    v_pk_add_f32 v[4:5], v[4:5], v[10:11]
    v_pk_add_f32 v[4:5], v[4:5], v[12:13]
    v_pk_add_f32 v[4:5], v[4:5], v[14:15]
    v_pk_add_f32 v[4:5], v[4:5], v[16:17]
    v_pk_add_f32 v[4:5], v[4:5], v[18:19]
    v_cmp_u_f32 vcc, v4, v5
    s_cbranch_vccz L_csx
    s_add_u32 s3, s3, 1
    s_cmp_gt_u32 s3, 20000
    s_cbranch_scc1 L_csx
    buffer_load_dwordx2 v[4:5], v126, s[36:39], s72 offen offset:0 sc1
    buffer_load_dwordx2 v[6:7], v126, s[36:39], s72 offen offset:512 sc1
    buffer_load_dwordx2 v[8:9], v126, s[36:39], s72 offen offset:1024 sc1
    buffer_load_dwordx2 v[10:11], v126, s[36:39], s72 offen offset:1536 sc1
    buffer_load_dwordx2 v[12:13], v126, s[36:39], s73 offen offset:0 sc1
    buffer_load_dwordx2 v[14:15], v126, s[36:39], s73 offen offset:512 sc1
    buffer_load_dwordx2 v[16:17], v126, s[36:39], s73 offen offset:1024 sc1
    buffer_load_dwordx2 v[18:19], v126, s[36:39], s73 offen offset:1536 sc1
    buffer_load_dword v23, v21, s[36:39], s74 offen sc1
    buffer_load_dwordx4 v[24:27], v22, s[36:39], s70 offen offset:0 sc1
    buffer_load_dwordx4 v[28:31], v22, s[36:39], s70 offen offset:1024 sc1
    buffer_load_dwordx4 v[32:35], v22, s[36:39], s70 offen offset:2048 sc1
    buffer_load_dwordx4 v[36:39], v22, s[36:39], s70 offen offset:3072 sc1
    buffer_load_dwordx4 v[40:43], v22, s[36:39], s71 offen offset:0 sc1
    buffer_load_dwordx4 v[44:47], v22, s[36:39], s71 offen offset:1024 sc1
    buffer_load_dwordx4 v[48:51], v22, s[36:39], s71 offen offset:2048 sc1
    buffer_load_dwordx4 v[52:55], v22, s[36:39], s71 offen offset:3072 sc1
    s_waitcnt vmcnt(9)
    s_branch L_cs
L_csx:
    s_mov_b32 vcc_lo, 0x55555555
    s_mov_b32 vcc_hi, 0x55555555
    s_mov_b32 s3, 0
    v_mul_f32 v124, 0xbb000000, v4
    v_mul_f32 v14, 0xbb000000, v5
    v_mov_b32 v125, v124
    v_mov_b32 v15, v14
    v_mov_b32 v4, 0
    v_mov_b32 v5, 0
    v_mov_b32 v6, 0
    v_mov_b32 v7, 0
    v_mov_b32 v8, 0
    v_mov_b32 v9, 0
    v_mov_b32 v10, 0
    v_mov_b32 v11, 0
    s_waitcnt lgkmcnt(0)
    s_branch L_xd1
L_xd:
    buffer_load_dword v23, v21, s[36:39], s74 offen sc1
    buffer_load_dwordx4 v[24:27], v22, s[36:39], s70 offen offset:0 sc1
    buffer_load_dwordx4 v[28:31], v22, s[36:39], s70 offen offset:1024 sc1
    buffer_load_dwordx4 v[32:35], v22, s[36:39], s70 offen offset:2048 sc1
    buffer_load_dwordx4 v[36:39], v22, s[36:39], s70 offen offset:3072 sc1
    buffer_load_dwordx4 v[40:43], v22, s[36:39], s71 offen offset:0 sc1
    buffer_load_dwordx4 v[44:47], v22, s[36:39], s71 offen offset:1024 sc1
    buffer_load_dwordx4 v[48:51], v22, s[36:39], s71 offen offset:2048 sc1
    buffer_load_dwordx4 v[52:55], v22, s[36:39], s71 offen offset:3072 sc1
L_xd1:
    s_add_u32 s3, s3, 1
    s_cmp_gt_u32 s3, 20000
    s_cselect_b64 s[80:81], 0, -1
    v_mov_b32 v13, 0x3727c5ac
    s_waitcnt vmcnt(8)
    v_add_f32_dpp v12, v23, v23 quad_perm:[1,0,3,2] row_mask:0xf bank_mask:0xf
    s_waitcnt vmcnt(6)
    v_pk_add_f32 v[16:17], v[24:25], v[28:29]
    v_pk_add_f32 v[18:19], v[26:27], v[30:31]
    v_add_f32_dpp v12, v12, v12 quad_perm:[2,3,0,1] row_mask:0xf bank_mask:0xf
    s_waitcnt vmcnt(5)
    v_pk_add_f32 v[16:17], v[16:17], v[32:33]
    v_pk_add_f32 v[18:19], v[18:19], v[34:35]
    v_add_f32_dpp v12, v12, v12 row_half_mirror row_mask:0xf bank_mask:0xf
    v_mov_b32 v20, v12
    s_waitcnt vmcnt(4)
    v_pk_add_f32 v[16:17], v[16:17], v[36:37]
    v_pk_add_f32 v[18:19], v[18:19], v[38:39]
    v_permlane16_swap_b32 v12, v20
    v_add_f32 v12, v12, v20
    v_mov_b32 v20, v12
    s_waitcnt vmcnt(3)
    v_pk_add_f32 v[16:17], v[16:17], v[40:41]
    v_pk_add_f32 v[18:19], v[18:19], v[42:43]
    v_permlane32_swap_b32 v12, v20
    s_waitcnt vmcnt(2)
    v_pk_add_f32 v[16:17], v[16:17], v[44:45]
    v_pk_add_f32 v[18:19], v[18:19], v[46:47]
    v_mov_b32_dpp v122, v20 row_newbcast:0 row_mask:0xf bank_mask:0xf
    v_mov_b32_dpp v123, v20 row_newbcast:8 row_mask:0xf bank_mask:0xf
    v_fmac_f32 v13, 0x3b000000, v12
    v_mul_f32 v3, 0x3b000000, v20
    v_pk_fma_f32 v[16:17], v[122:123], v[124:125], v[16:17]
    v_pk_fma_f32 v[18:19], v[122:123], v[14:15], v[18:19]
    v_fma_f32 v13, -v3, v3, v13
    s_waitcnt vmcnt(1)
    v_pk_add_f32 v[16:17], v[16:17], v[48:49]
    v_pk_add_f32 v[18:19], v[18:19], v[50:51]
    s_waitcnt vmcnt(0)
    v_pk_add_f32 v[16:17], v[16:17], v[52:53]
    v_pk_add_f32 v[18:19], v[18:19], v[54:55]
    v_pk_mul_f32 v[16:17], v[16:17], v[18:19]
    v_add_f32 v3, v16, v13
    v_cmp_u_f32 s[82:83], v3, v17
    s_and_b64 s[82:83], s[82:83], s[80:81]
    s_cbranch_scc1 L_xd
    v_cndmask_b32_dpp v18, v17, v16, vcc quad_perm:[0,0,2,2] row_mask:0xf bank_mask:0xf
    s_not_b64 vcc, vcc
    v_cndmask_b32_dpp v19, v16, v17, vcc quad_perm:[1,1,3,3] row_mask:0xf bank_mask:0xf
    s_mov_b64 vcc, s[56:57]
    v_cvt_pk_bf16_f32 v16, v18, v19
    v_max_f32 v3, 0x3727c5ac, v13
    v_rcp_f32 v3, v3
    v_cndmask_b32_dpp v124, v16, v2, vcc quad_perm:[0,1,2,3] row_mask:0xf bank_mask:0xf
    v_cndmask_b32_dpp v125, v16, v2, vcc row_ror:12 row_mask:0xf bank_mask:0xf
    v_cndmask_b32_dpp v126, v16, v2, vcc row_ror:8 row_mask:0xf bank_mask:0xf
    v_cndmask_b32_dpp v127, v16, v2, vcc row_ror:4 row_mask:0xf bank_mask:0xf
    s_mov_b64 vcc, s[58:59]
    v_cndmask_b32_dpp v18, v16, v2, vcc row_ror:4 row_mask:0xf bank_mask:0xf
    v_cndmask_b32_dpp v19, v16, v2, vcc quad_perm:[0,1,2,3] row_mask:0xf bank_mask:0xf
    v_smfmac_f32_16x16x64_bf16 v[4:7], v[124:127], v[56:63], v1
    v_cndmask_b32_dpp v20, v16, v2, vcc row_ror:12 row_mask:0xf bank_mask:0xf
    v_cndmask_b32_dpp v21, v16, v2, vcc row_ror:8 row_mask:0xf bank_mask:0xf
    s_mov_b64 vcc, s[60:61]
    v_smfmac_f32_16x16x64_bf16 v[8:11], v[124:127], v[88:95], v1
    v_cndmask_b32_dpp v12, v16, v2, vcc row_ror:8 row_mask:0xf bank_mask:0xf
    v_cndmask_b32_dpp v13, v16, v2, vcc row_ror:4 row_mask:0xf bank_mask:0xf
    v_smfmac_f32_16x16x64_bf16 v[4:7], v[18:21], v[64:71], v1
    v_cndmask_b32_dpp v14, v16, v2, vcc quad_perm:[0,1,2,3] row_mask:0xf bank_mask:0xf
    v_cndmask_b32_dpp v15, v16, v2, vcc row_ror:12 row_mask:0xf bank_mask:0xf
    s_mov_b64 vcc, s[62:63]
    v_smfmac_f32_16x16x64_bf16 v[8:11], v[18:21], v[96:103], v1
    v_cndmask_b32_dpp v124, v16, v2, vcc row_ror:12 row_mask:0xf bank_mask:0xf
    v_cndmask_b32_dpp v125, v16, v2, vcc row_ror:8 row_mask:0xf bank_mask:0xf
    v_smfmac_f32_16x16x64_bf16 v[4:7], v[12:15], v[72:79], v1
    v_cndmask_b32_dpp v126, v16, v2, vcc row_ror:4 row_mask:0xf bank_mask:0xf
    v_cndmask_b32_dpp v127, v16, v2, vcc quad_perm:[0,1,2,3] row_mask:0xf bank_mask:0xf
    v_smfmac_f32_16x16x64_bf16 v[8:11], v[12:15], v[104:111], v1
    v_mov_b32_dpp v120, v3 row_newbcast:0 row_mask:0xf bank_mask:0xf
    v_mov_b32_dpp v121, v3 row_newbcast:8 row_mask:0xf bank_mask:0xf
    v_smfmac_f32_16x16x64_bf16 v[4:7], v[124:127], v[80:87], v1
    v_smfmac_f32_16x16x64_bf16 v[8:11], v[124:127], v[112:119], v1
    s_nop 6
    v_pk_add_f32 v[16:17], v[4:5], v[6:7]
    v_pk_add_f32 v[18:19], v[8:9], v[10:11]
    v_pk_mul_f32 v[16:17], v[16:17], v[120:121]
    v_pk_mul_f32 v[18:19], v[18:19], v[120:121]
    buffer_store_dwordx4 v[16:19], v22, s[36:39], s76 offen sc1
    buffer_store_dwordx4 v[16:19], v22, s[36:39], s77 offen sc1
    s_endpgm
L_exit2:
L_exit:
    s_endpgm
.section .rodata,"a"
.p2align 6
.amdhsa_kernel sequential_preLN__sliding_block_cached__glu_gated_bilinear__decode_kernel
.amdhsa_next_free_vgpr 128
.amdhsa_next_free_sgpr 102
.amdhsa_accum_offset 128
.amdhsa_group_segment_fixed_size 0
.amdhsa_kernarg_size 96
.amdhsa_user_sgpr_count 2
.amdhsa_user_sgpr_kernarg_segment_ptr 1
.amdhsa_system_sgpr_workgroup_id_x 1
.amdhsa_float_denorm_mode_32 3
.end_amdhsa_kernel
```
